```python
import torch

def _softmax(x, axis=-1):
    return torch.softmax(x, dim=axis)
def _gelu(x):
    return torch.nn.functional.gelu(x, approximate="tanh")
def _silu(x):
    return torch.nn.functional.silu(x)
def _sigmoid(x):
    return torch.sigmoid(x)
def _layernorm(x, axis=-1, eps=1e-5):
    m = x.mean(dim=axis, keepdim=True)
    v = x.var(dim=axis, keepdim=True, unbiased=False)
    return (x - m) / torch.sqrt(v + eps)
def _scatter_add(tgt, idx, src, axis=0):
    return tgt.clone().index_add_(axis, idx, src)
def _segment_sum(src, seg, n):
    out = torch.zeros((n,) + src.shape[1:], dtype=src.dtype)
    return out.index_add_(0, seg, src)
def _pad(x, pw):
    flat = tuple(v for pair in reversed(pw) for v in pair)
    return torch.nn.functional.pad(x, flat)

kernel_name = 'gated_mix__grouped_kv_mqa__glu_gated_swiglu__prompt'

def setup_inputs():

    _w = (lambda a: (lambda t: t.to(torch.bfloat16) if t.is_floating_point() else t)(torch.as_tensor(a)))
    def _A_setup():
        B, S, D, H = 1, 2048, 640, 32
        Dh = D // H
        return {
            "x": _w((lambda *s: torch.randn(*s, dtype=torch.bfloat16) * 0.05)(B, S, D)),
            "wq": _w((lambda *s: torch.randn(*s, dtype=torch.bfloat16) * 0.8)(D, H * Dh)),
            "wk": _w((lambda *s: torch.randn(*s, dtype=torch.bfloat16) * 0.8)(D, Dh)),
            "wv": _w((lambda *s: torch.randn(*s, dtype=torch.bfloat16) * 0.05)(D, Dh)),
            "wo": _w((lambda *s: torch.randn(*s, dtype=torch.bfloat16) * 0.05)(H * Dh, D)),
        }
    _A_in = _A_setup()

    def _B_setup():
        B, S, D, F = 1, 2048, 640, 1536
        return {
            "x": _w((lambda *s: torch.randn(*s, dtype=torch.bfloat16) * 0.05)(B, S, D)),
            "w1": _w((lambda *s: torch.randn(*s, dtype=torch.bfloat16) * 0.8)(D, F) * (2.0 / D) ** 0.5),
            "w3": _w((lambda *s: torch.randn(*s, dtype=torch.bfloat16) * 0.8)(D, F) * (2.0 / D) ** 0.5),
            "w2": _w((lambda *s: torch.randn(*s, dtype=torch.bfloat16) * 0.8)(F, D) * (2.0 / F) ** 0.5),
        }
    _B_in = _B_setup()

    return {
        "A_x": _A_in["x"],
        "A_wq": _A_in["wq"],
        "A_wk": _A_in["wk"],
        "A_wv": _A_in["wv"],
        "A_wo": _A_in["wo"],
        "B_x": _B_in["x"],
        "B_w1": _B_in["w1"],
        "B_w3": _B_in["w3"],
        "B_w2": _B_in["w2"],
        "gate_w": _w((lambda *s: torch.randn(*s, dtype=torch.bfloat16) * 0.05)(640) * 16.0),
    }

def reference(A_x, A_wq, A_wk, A_wv, A_wo, B_x, B_w1, B_w3, B_w2, gate_w):
    def _A_ref(x, wq, wk, wv, wo):
        B, S, D = x.shape
        H = 32
        Dh = D // H
        q = (lambda x, *d: x.permute(*d))((x @ wq).reshape(B, S, H, Dh), 0, 2, 1, 3)
        k = x @ wk
        v = x @ wv
        scores = torch.einsum("bhqd,bkd->bhqk", q, k) * (Dh ** -0.5)
        p = _softmax(scores, axis=-1)
        o = torch.einsum("bhqk,bkd->bhqd", p, v)
        return (lambda x, *d: x.permute(*d))(o, 0, 2, 1, 3).reshape(B, S, H * Dh) @ wo

    def _B_ref(x, w1, w3, w2):
        gate = torch.einsum("bsd,df->bsf", x, w1)
        up = torch.einsum("bsd,df->bsf", x, w3)
        h = _silu(gate) * up
        out = torch.einsum("bsf,fd->bsd", h, w2)
        return out

    x = A_x
    g = _sigmoid((x * gate_w).sum(-1, keepdims=True))
    a = _A_ref(x, A_wq, A_wk, A_wv, A_wo)
    b = _B_ref(x, B_w1, B_w3, B_w2)
    return g * a + (1 - g) * b
```

```asm
; @launch kernel=k1_kernel grid=(256,1,1) block=(256,1,1) lds=163840
; @launch kernel=kd_kernel grid=(256,1,1) block=(512,1,1) lds=106560
; @launch kernel=ke_kernel grid=(256,1,1) block=(256,1,1) lds=81920
.amdgcn_target "amdgcn-amd-amdhsa--gfx950"
.text
.globl k1_kernel
.p2align 8
.type k1_kernel,@function
k1_kernel:

  s_cmp_ge_u32 s2, 256
  s_cbranch_scc1 k1_kernel_end
  s_load_dwordx16 s[40:55], s[0:1], 0
  s_load_dwordx4 s[56:59], s[0:1], 64
  s_load_dwordx2 s[60:61], s[0:1], 96
  v_lshrrev_b32 v1, 6, v0
  v_and_b32 v63, 63, v0
  v_readfirstlane_b32 s20, v1
  s_and_b32 s3, s2, 7
  s_lshr_b32 s62, s2, 3
  s_and_b32 s63, s3, 1
  s_lshr_b32 s64, s3, 1
  s_and_b32 s65, s62, 3
  s_lshl_b32 s21, s63, 2
  s_add_u32 s21, s21, s65
  s_lshr_b32 s66, s62, 2
  s_waitcnt lgkmcnt(0)
  s_mov_b32 s16, s60
  s_and_b32 s17, s61, 0xffff
  s_mov_b32 s18, 23068672
  s_mov_b32 s19, 0x20000
  s_mov_b32 s4, s40
  s_and_b32 s5, s41, 0xffff
  s_mov_b32 s6, 2621440
  s_mov_b32 s7, 0x20000
  s_mul_i32 s22, s64, 7
  s_add_u32 s22, s22, 1
  s_cmp_eq_u32 s64, 0
  s_cselect_b32 s22, 0, s22
  s_add_u32 s22, s22, s66
  s_cmp_eq_u32 s66, 7
  s_cselect_b32 s67, 1, 0
  s_cmp_lg_u32 s64, 0
  s_cselect_b32 s68, 1, 0
  s_and_b32 s67, s67, s68
  s_cmp_lg_u32 s67, 0
  s_cbranch_scc1 k1_kernel_spare
  s_cmp_lt_u32 s22, 5
  s_cselect_b32 s69, 1, 0
  s_cbranch_scc0 k1_kernel_ffn_setup
  s_lshl_b32 s70, s22, 8
  s_add_u32 s8, s42, s70
  s_addc_u32 s9, s43, 0
  s_add_u32 s12, s8, 128
  s_addc_u32 s13, s9, 0
  s_mov_b32 s23, 1280
  s_branch k1_kernel_setup_done
k1_kernel_ffn_setup:
  s_sub_u32 s70, s22, 5
  s_lshl_b32 s70, s70, 7
  s_add_u32 s8, s52, s70
  s_addc_u32 s9, s53, 0
  s_add_u32 s12, s54, s70
  s_addc_u32 s13, s55, 0
  s_mov_b32 s23, 3072
k1_kernel_setup_done:
  s_and_b32 s9, s9, 0xffff
  s_and_b32 s13, s13, 0xffff
  s_lshl_b32 s38, s23, 6
  s_mov_b32 s10, s38
  s_mov_b32 s11, 0x20000
  s_mov_b32 s14, s38
  s_mov_b32 s15, 0x20000
  s_lshr_b32 s70, s20, 1
  s_cmp_eq_u32 s70, 0
  s_cselect_b32 s72, s8, s12
  s_cselect_b32 s73, s9, s13
  s_mov_b32 s74, s38
  s_mov_b32 s75, 0x20000
  s_lshl_b32 s24, s20, 13
  s_lshl_b32 s25, s70, 13
  s_and_b32 s71, s20, 1
  s_lshl_b32 s39, s71, 12
  s_add_u32 s25, s25, s39
  s_add_u32 s25, s25, 98304
  s_lshl_b32 s26, s21, 8
  s_lshl_b32 s39, s20, 6
  s_add_u32 s26, s26, s39
  s_mul_i32 s26, s26, 1280
  s_add_u32 s27, s26, 10240
  s_add_u32 s28, s26, 20480
  s_add_u32 s29, s26, 30720
  s_add_u32 s30, s26, 40960
  s_add_u32 s31, s26, 51200
  s_add_u32 s32, s26, 61440
  s_add_u32 s33, s26, 71680
  s_lshl_b32 s39, s71, 5
  s_mul_i32 s34, s39, s23
  s_lshl_b32 s39, s23, 3
  s_add_u32 s35, s34, s39
  s_add_u32 s36, s35, s39
  s_add_u32 s37, s36, s39
  v_lshrrev_b32 v14, 3, v63
  v_and_b32 v15, 7, v63
  v_lshrrev_b32 v16, 4, v63
  s_movk_i32 s39, 1280
  v_mul_lo_u32 v17, v14, s39
  v_xor_b32 v18, v15, v16
  v_lshl_add_u32 v11, v18, 4, v17
  v_xor_b32 v18, 4, v18
  v_lshl_add_u32 v12, v18, 4, v17
  v_mul_lo_u32 v17, v14, s23
  v_and_b32 v18, 1, v16
  v_lshlrev_b32 v18, 2, v18
  v_xor_b32 v18, v15, v18
  v_lshl_add_u32 v13, v18, 4, v17
  s_add_u32 m0, s25, 0
  s_nop 0
  buffer_load_dwordx4 v13, s[72:75], s34 offen lds
  s_lshr_b32 s76, s20, 1
  s_and_b32 s77, s20, 1
  v_and_b32 v14, 31, v63
  v_lshrrev_b32 v15, 5, v63
  v_lshrrev_b32 v16, 1, v14
  v_and_b32 v16, 7, v16
  v_xor_b32 v16, v16, v15
  s_add_u32 m0, s24, 0
  s_nop 0
  buffer_load_dwordx4 v11, s[4:7], s26 offen lds
  s_lshl_b32 s39, s76, 7
  v_add_u32 v17, s39, v14
  v_lshlrev_b32 v17, 7, v17
  v_xor_b32 v18, 0, v16
  v_lshl_add_u32 v2, v18, 4, v17
  v_add_u32 v6, 0x10000, v2
  v_xor_b32 v18, 2, v16
  s_add_u32 m0, s24, 1024
  s_nop 0
  buffer_load_dwordx4 v12, s[4:7], s27 offen lds
  v_lshl_add_u32 v3, v18, 4, v17
  v_add_u32 v7, 0x10000, v3
  v_xor_b32 v18, 4, v16
  v_lshl_add_u32 v4, v18, 4, v17
  v_add_u32 v8, 0x10000, v4
  v_xor_b32 v18, 6, v16
  v_lshl_add_u32 v5, v18, 4, v17
  s_add_u32 m0, s25, 1024
  s_nop 0
  buffer_load_dwordx4 v13, s[72:75], s35 offen lds
  v_add_u32 v9, 0x10000, v5
  v_and_b32 v14, 15, v63
  v_lshrrev_b32 v16, 2, v14
  v_and_b32 v17, 3, v14
  v_bfe_u32 v18, v63, 4, 1
  v_lshlrev_b32 v18, 1, v18
  v_lshrrev_b32 v19, 1, v17
  s_add_u32 m0, s24, 2048
  s_nop 0
  buffer_load_dwordx4 v11, s[4:7], s28 offen lds
  v_add_u32 v18, v18, v19
  s_lshl_b32 s39, s77, 2
  v_add_u32 v18, s39, v18
  v_bfe_u32 v19, v16, 1, 1
  v_lshlrev_b32 v19, 2, v19
  v_xor_b32 v18, v18, v19
  v_lshlrev_b32 v18, 4, v18
  s_add_u32 m0, s24, 3072
  s_nop 0
  buffer_load_dwordx4 v12, s[4:7], s29 offen lds
  v_and_b32 v17, 1, v17
  v_lshl_add_u32 v18, v17, 3, v18
  v_lshl_add_u32 v16, v15, 3, v16
  v_lshl_add_u32 v18, v16, 7, v18
  v_add_u32 v10, 98304, v18
  v_and_b32 v14, 31, v63
  s_lshl_b32 s78, s22, 5
  s_add_u32 m0, s25, 2048
  s_nop 0
  buffer_load_dwordx4 v13, s[72:75], s36 offen lds
  s_lshl_b32 s39, s77, 3
  s_add_u32 s78, s78, s39
  v_add_u32 v16, s78, v15
  s_lshl_b32 s86, s21, 3
  s_lshl_b32 s39, s76, 2
  s_add_u32 s86, s86, s39
  s_mul_i32 s86, s86, 1280
  s_add_u32 m0, s24, 4096
  s_nop 0
  buffer_load_dwordx4 v11, s[4:7], s30 offen lds
  s_add_u32 s86, s86, 0
  s_mov_b32 s84, 52429
  s_mov_b32 s85, 81920
  v_add_u32 v17, 0, v16
  v_mul_u32_u24 v18, s84, v17
  v_lshrrev_b32 v18, 18, v18
  v_mul_u32_u24 v19, 5, v18
  s_add_u32 m0, s24, 5120
  s_nop 0
  buffer_load_dwordx4 v12, s[4:7], s31 offen lds
  v_sub_u32 v19, v17, v19
  v_mul_lo_u32 v18, v18, s85
  v_lshlrev_b32 v29, 3, v14
  v_lshl_add_u32 v28, v19, 8, v29
  v_add_u32 v20, v18, v28
  v_add_u32 v17, 2, v16
  v_mul_u32_u24 v18, s84, v17
  s_add_u32 m0, s25, 3072
  s_nop 0
  buffer_load_dwordx4 v13, s[72:75], s37 offen lds
  v_lshrrev_b32 v18, 18, v18
  v_mul_u32_u24 v19, 5, v18
  v_sub_u32 v19, v17, v19
  v_mul_lo_u32 v18, v18, s85
  v_lshlrev_b32 v29, 3, v14
  v_lshl_add_u32 v28, v19, 8, v29
  v_add_u32 v21, v18, v28
  s_add_u32 m0, s24, 6144
  s_nop 0
  buffer_load_dwordx4 v11, s[4:7], s32 offen lds
  v_add_u32 v17, 4, v16
  v_mul_u32_u24 v18, s84, v17
  v_lshrrev_b32 v18, 18, v18
  v_mul_u32_u24 v19, 5, v18
  v_sub_u32 v19, v17, v19
  v_mul_lo_u32 v18, v18, s85
  v_lshlrev_b32 v29, 3, v14
  s_add_u32 m0, s24, 7168
  s_nop 0
  buffer_load_dwordx4 v12, s[4:7], s33 offen lds
  v_lshl_add_u32 v28, v19, 8, v29
  v_add_u32 v22, v18, v28
  v_add_u32 v17, 6, v16
  v_mul_u32_u24 v18, s84, v17
  v_lshrrev_b32 v18, 18, v18
  v_mul_u32_u24 v19, 5, v18
  v_sub_u32 v19, v17, v19
  s_add_u32 s4, s4, 128
  s_addc_u32 s5, s5, 0
  s_add_u32 s72, s72, s38
  s_addc_u32 s73, s73, 0
  s_add_u32 m0, s25, 16384
  s_nop 0
  buffer_load_dwordx4 v13, s[72:75], s34 offen lds
  v_mul_lo_u32 v18, v18, s85
  v_lshlrev_b32 v29, 3, v14
  v_lshl_add_u32 v28, v19, 8, v29
  v_add_u32 v23, v18, v28
  v_add_u32 v17, 16, v16
  v_mul_u32_u24 v18, s84, v17
  v_lshrrev_b32 v18, 18, v18
  s_add_u32 m0, s24, 32768
  s_nop 0
  buffer_load_dwordx4 v11, s[4:7], s26 offen lds
  v_mul_u32_u24 v19, 5, v18
  v_sub_u32 v19, v17, v19
  v_mul_lo_u32 v18, v18, s85
  v_lshlrev_b32 v29, 3, v14
  v_lshl_add_u32 v28, v19, 8, v29
  v_add_u32 v24, v18, v28
  v_add_u32 v17, 18, v16
  s_add_u32 m0, s24, 33792
  s_nop 0
  buffer_load_dwordx4 v12, s[4:7], s27 offen lds
  v_mul_u32_u24 v18, s84, v17
  v_lshrrev_b32 v18, 18, v18
  v_mul_u32_u24 v19, 5, v18
  v_sub_u32 v19, v17, v19
  v_mul_lo_u32 v18, v18, s85
  v_lshlrev_b32 v29, 3, v14
  v_lshl_add_u32 v28, v19, 8, v29
  s_add_u32 m0, s25, 17408
  s_nop 0
  buffer_load_dwordx4 v13, s[72:75], s35 offen lds
  v_add_u32 v25, v18, v28
  v_add_u32 v17, 20, v16
  v_mul_u32_u24 v18, s84, v17
  v_lshrrev_b32 v18, 18, v18
  v_mul_u32_u24 v19, 5, v18
  v_sub_u32 v19, v17, v19
  v_mul_lo_u32 v18, v18, s85
  s_add_u32 m0, s24, 34816
  s_nop 0
  buffer_load_dwordx4 v11, s[4:7], s28 offen lds
  v_lshlrev_b32 v29, 3, v14
  v_lshl_add_u32 v28, v19, 8, v29
  v_add_u32 v26, v18, v28
  v_add_u32 v17, 22, v16
  v_mul_u32_u24 v18, s84, v17
  v_lshrrev_b32 v18, 18, v18
  v_mul_u32_u24 v19, 5, v18
  s_add_u32 m0, s24, 35840
  s_nop 0
  buffer_load_dwordx4 v12, s[4:7], s29 offen lds
  v_sub_u32 v19, v17, v19
  v_mul_lo_u32 v18, v18, s85
  v_lshlrev_b32 v29, 3, v14
  v_lshl_add_u32 v28, v19, 8, v29
  v_add_u32 v27, v18, v28
  v_and_b32 v14, 31, v63
  v_lshrrev_b32 v16, 4, v14
  s_add_u32 m0, s25, 18432
  s_nop 0
  buffer_load_dwordx4 v13, s[72:75], s36 offen lds
  s_mov_b32 s39, 49152
  v_mul_lo_u32 v16, v16, s39
  v_and_b32 v17, 15, v14
  v_lshl_add_u32 v16, v17, 4, v16
  v_lshl_add_u32 v16, v15, 9, v16
  s_lshl_b32 s78, s21, 3
  s_lshl_b32 s39, s76, 2
  s_add_u32 m0, s24, 36864
  s_nop 0
  buffer_load_dwordx4 v11, s[4:7], s30 offen lds
  s_add_u32 s78, s78, s39
  s_mul_i32 s78, s78, 98304
  s_sub_u32 s79, s22, 5
  s_lshl_b32 s79, s79, 1
  s_add_u32 s79, s79, s77
  s_lshl_b32 s79, s79, 10
  s_add_u32 s78, s78, s79
  s_add_u32 m0, s24, 37888
  s_nop 0
  buffer_load_dwordx4 v12, s[4:7], s31 offen lds
  s_add_u32 s78, s78, 3145728
  s_mov_b32 s80, 3216550459
  s_mov_b32 s81, s80
  s_mov_b32 s82, 1.0
  s_mov_b32 s83, 1.0
  s_add_u32 m0, s25, 19456
  s_nop 0
  buffer_load_dwordx4 v13, s[72:75], s37 offen lds
  s_add_u32 m0, s24, 38912
  s_nop 0
  buffer_load_dwordx4 v11, s[4:7], s32 offen lds
  s_add_u32 m0, s24, 39936
  s_nop 0
  buffer_load_dwordx4 v12, s[4:7], s33 offen lds
  s_add_u32 s4, s4, 128
  s_addc_u32 s5, s5, 0
  s_add_u32 s72, s72, s38
  s_addc_u32 s73, s73, 0
  v_and_b32 v30, 15, v63
  v_lshrrev_b32 v31, 4, v63
  s_lshl_b32 s39, s65, 4
  v_add_u32 v30, s39, v30
  v_lshl_add_u32 v30, v31, 6, v30
  v_mul_lo_u32 v30, v30, s23
  s_and_b32 s48, s20, 1
  s_cmp_eq_u32 s48, 0
  s_cselect_b32 s44, s8, s12
  s_cselect_b32 s45, s9, s13
  s_lshr_b32 s48, s44, 7
  s_and_b32 s48, s48, 7
  s_lshl_b32 s39, s38, 1
  s_add_u32 s44, s44, s39
  s_addc_u32 s45, s45, 0
  s_lshl_b32 s46, s38, 3
  s_sub_u32 s46, s46, s23
  s_add_u32 s46, s46, 128
  s_cmp_eq_u32 s48, 3
  s_cselect_b32 s46, s46, 0
  s_cmp_eq_u32 s69, 0
  s_cselect_b32 s46, s46, 0
  s_mov_b32 s47, 0x20000
  s_lshr_b32 s48, s20, 1
  s_lshl_b32 s39, s38, 2
  s_mul_i32 s48, s48, s39
  buffer_load_dword v31, v30, s[44:47], s48 offen
  s_waitcnt vmcnt(13)
  s_barrier
  ds_read_b64_tr_b16 v[80:81], v10 offset:0
  ds_read_b64_tr_b16 v[82:83], v10 offset:512
  ds_read_b128 v[64:67], v2 offset:0
  ds_read_b64_tr_b16 v[84:85], v10 offset:8192
  ds_read_b64_tr_b16 v[86:87], v10 offset:8704
  ds_read_b128 v[68:71], v2 offset:4096
  ds_read_b128 v[72:75], v2 offset:8192
  ds_read_b128 v[76:79], v2 offset:12288
  s_waitcnt lgkmcnt(0)
  v_mfma_f32_32x32x16_bf16 v[128:143], v[80:83], v[64:67], 0
  ds_read_b64_tr_b16 v[104:105], v10 offset:2048
  ds_read_b64_tr_b16 v[106:107], v10 offset:2560
  v_mfma_f32_32x32x16_bf16 v[144:159], v[84:87], v[64:67], 0
  ds_read_b128 v[88:91], v3 offset:0
  ds_read_b64_tr_b16 v[108:109], v10 offset:10240
  v_mfma_f32_32x32x16_bf16 v[160:175], v[80:83], v[68:71], 0
  ds_read_b64_tr_b16 v[110:111], v10 offset:10752
  ds_read_b128 v[92:95], v3 offset:4096
  v_mfma_f32_32x32x16_bf16 v[176:191], v[84:87], v[68:71], 0
  ds_read_b128 v[96:99], v3 offset:8192
  ds_read_b128 v[100:103], v3 offset:12288
  v_mfma_f32_32x32x16_bf16 v[192:207], v[80:83], v[72:75], 0
  s_add_u32 m0, s25, 32768
  s_nop 0
  buffer_load_dwordx4 v13, s[72:75], s34 offen lds
  v_mfma_f32_32x32x16_bf16 v[208:223], v[84:87], v[72:75], 0
  s_add_u32 m0, s24, 65536
  s_nop 0
  buffer_load_dwordx4 v11, s[4:7], s26 offen lds
  v_mfma_f32_32x32x16_bf16 v[224:239], v[80:83], v[76:79], 0
  s_add_u32 m0, s24, 66560
  s_nop 0
  buffer_load_dwordx4 v12, s[4:7], s27 offen lds
  v_mfma_f32_32x32x16_bf16 v[240:255], v[84:87], v[76:79], 0
  s_add_u32 m0, s25, 33792
  s_nop 0
  buffer_load_dwordx4 v13, s[72:75], s35 offen lds
  s_waitcnt lgkmcnt(0)
  v_mfma_f32_32x32x16_bf16 v[128:143], v[104:107], v[88:91], v[128:143]
  ds_read_b64_tr_b16 v[80:81], v10 offset:4096
  ds_read_b64_tr_b16 v[82:83], v10 offset:4608
  v_mfma_f32_32x32x16_bf16 v[144:159], v[108:111], v[88:91], v[144:159]
  ds_read_b128 v[64:67], v4 offset:0
  ds_read_b64_tr_b16 v[84:85], v10 offset:12288
  v_mfma_f32_32x32x16_bf16 v[160:175], v[104:107], v[92:95], v[160:175]
  ds_read_b64_tr_b16 v[86:87], v10 offset:12800
  ds_read_b128 v[68:71], v4 offset:4096
  v_mfma_f32_32x32x16_bf16 v[176:191], v[108:111], v[92:95], v[176:191]
  ds_read_b128 v[72:75], v4 offset:8192
  ds_read_b128 v[76:79], v4 offset:12288
  v_mfma_f32_32x32x16_bf16 v[192:207], v[104:107], v[96:99], v[192:207]
  s_add_u32 m0, s24, 67584
  s_nop 0
  buffer_load_dwordx4 v11, s[4:7], s28 offen lds
  v_mfma_f32_32x32x16_bf16 v[208:223], v[108:111], v[96:99], v[208:223]
  s_add_u32 m0, s24, 68608
  s_nop 0
  buffer_load_dwordx4 v12, s[4:7], s29 offen lds
  v_mfma_f32_32x32x16_bf16 v[224:239], v[104:107], v[100:103], v[224:239]
  s_add_u32 m0, s25, 34816
  s_nop 0
  buffer_load_dwordx4 v13, s[72:75], s36 offen lds
  v_mfma_f32_32x32x16_bf16 v[240:255], v[108:111], v[100:103], v[240:255]
  s_add_u32 m0, s24, 69632
  s_nop 0
  buffer_load_dwordx4 v11, s[4:7], s30 offen lds
  s_waitcnt lgkmcnt(0)
  v_mfma_f32_32x32x16_bf16 v[128:143], v[80:83], v[64:67], v[128:143]
  ds_read_b64_tr_b16 v[104:105], v10 offset:6144
  ds_read_b64_tr_b16 v[106:107], v10 offset:6656
  v_mfma_f32_32x32x16_bf16 v[144:159], v[84:87], v[64:67], v[144:159]
  ds_read_b128 v[88:91], v5 offset:0
  ds_read_b64_tr_b16 v[108:109], v10 offset:14336
  v_mfma_f32_32x32x16_bf16 v[160:175], v[80:83], v[68:71], v[160:175]
  ds_read_b64_tr_b16 v[110:111], v10 offset:14848
  ds_read_b128 v[92:95], v5 offset:4096
  v_mfma_f32_32x32x16_bf16 v[176:191], v[84:87], v[68:71], v[176:191]
  ds_read_b128 v[96:99], v5 offset:8192
  ds_read_b128 v[100:103], v5 offset:12288
  v_mfma_f32_32x32x16_bf16 v[192:207], v[80:83], v[72:75], v[192:207]
  s_add_u32 m0, s24, 70656
  s_nop 0
  buffer_load_dwordx4 v12, s[4:7], s31 offen lds
  v_mfma_f32_32x32x16_bf16 v[208:223], v[84:87], v[72:75], v[208:223]
  s_add_u32 m0, s25, 35840
  s_nop 0
  buffer_load_dwordx4 v13, s[72:75], s37 offen lds
  v_mfma_f32_32x32x16_bf16 v[224:239], v[80:83], v[76:79], v[224:239]
  s_add_u32 m0, s24, 71680
  s_nop 0
  buffer_load_dwordx4 v11, s[4:7], s32 offen lds
  v_mfma_f32_32x32x16_bf16 v[240:255], v[84:87], v[76:79], v[240:255]
  s_add_u32 m0, s24, 72704
  s_nop 0
  buffer_load_dwordx4 v12, s[4:7], s33 offen lds
  s_add_u32 s4, s4, 128
  s_addc_u32 s5, s5, 0
  s_add_u32 s72, s72, s38
  s_addc_u32 s73, s73, 0
  s_waitcnt lgkmcnt(0)
  s_waitcnt vmcnt(13)
  s_barrier
  v_mfma_f32_32x32x16_bf16 v[128:143], v[104:107], v[88:91], v[128:143]
  ds_read_b64_tr_b16 v[80:81], v10 offset:16384
  ds_read_b64_tr_b16 v[82:83], v10 offset:16896
  v_mfma_f32_32x32x16_bf16 v[144:159], v[108:111], v[88:91], v[144:159]
  ds_read_b128 v[64:67], v2 offset:32768
  ds_read_b64_tr_b16 v[84:85], v10 offset:24576
  v_mfma_f32_32x32x16_bf16 v[160:175], v[104:107], v[92:95], v[160:175]
  ds_read_b64_tr_b16 v[86:87], v10 offset:25088
  ds_read_b128 v[68:71], v2 offset:36864
  v_mfma_f32_32x32x16_bf16 v[176:191], v[108:111], v[92:95], v[176:191]
  ds_read_b128 v[72:75], v2 offset:40960
  ds_read_b128 v[76:79], v2 offset:45056
  v_mfma_f32_32x32x16_bf16 v[192:207], v[104:107], v[96:99], v[192:207]
  s_add_u32 m0, s25, 0
  s_nop 0
  buffer_load_dwordx4 v13, s[72:75], s34 offen lds
  v_mfma_f32_32x32x16_bf16 v[208:223], v[108:111], v[96:99], v[208:223]
  s_add_u32 m0, s24, 0
  s_nop 0
  buffer_load_dwordx4 v11, s[4:7], s26 offen lds
  v_mfma_f32_32x32x16_bf16 v[224:239], v[104:107], v[100:103], v[224:239]
  s_add_u32 m0, s24, 1024
  s_nop 0
  buffer_load_dwordx4 v12, s[4:7], s27 offen lds
  v_mfma_f32_32x32x16_bf16 v[240:255], v[108:111], v[100:103], v[240:255]
  s_waitcnt lgkmcnt(0)
  v_mfma_f32_32x32x16_bf16 v[128:143], v[80:83], v[64:67], v[128:143]
  ds_read_b64_tr_b16 v[104:105], v10 offset:18432
  ds_read_b64_tr_b16 v[106:107], v10 offset:18944
  v_mfma_f32_32x32x16_bf16 v[144:159], v[84:87], v[64:67], v[144:159]
  ds_read_b128 v[88:91], v3 offset:32768
  ds_read_b64_tr_b16 v[108:109], v10 offset:26624
  v_mfma_f32_32x32x16_bf16 v[160:175], v[80:83], v[68:71], v[160:175]
  ds_read_b64_tr_b16 v[110:111], v10 offset:27136
  ds_read_b128 v[92:95], v3 offset:36864
  v_mfma_f32_32x32x16_bf16 v[176:191], v[84:87], v[68:71], v[176:191]
  ds_read_b128 v[96:99], v3 offset:40960
  ds_read_b128 v[100:103], v3 offset:45056
  v_mfma_f32_32x32x16_bf16 v[192:207], v[80:83], v[72:75], v[192:207]
  s_add_u32 m0, s25, 1024
  s_nop 0
  buffer_load_dwordx4 v13, s[72:75], s35 offen lds
  v_mfma_f32_32x32x16_bf16 v[208:223], v[84:87], v[72:75], v[208:223]
  s_add_u32 m0, s24, 2048
  s_nop 0
  buffer_load_dwordx4 v11, s[4:7], s28 offen lds
  v_mfma_f32_32x32x16_bf16 v[224:239], v[80:83], v[76:79], v[224:239]
  s_add_u32 m0, s24, 3072
  s_nop 0
  buffer_load_dwordx4 v12, s[4:7], s29 offen lds
  v_mfma_f32_32x32x16_bf16 v[240:255], v[84:87], v[76:79], v[240:255]
  s_waitcnt lgkmcnt(0)
  v_mfma_f32_32x32x16_bf16 v[128:143], v[104:107], v[88:91], v[128:143]
  ds_read_b64_tr_b16 v[80:81], v10 offset:20480
  ds_read_b64_tr_b16 v[82:83], v10 offset:20992
  v_mfma_f32_32x32x16_bf16 v[144:159], v[108:111], v[88:91], v[144:159]
  ds_read_b128 v[64:67], v4 offset:32768
  ds_read_b64_tr_b16 v[84:85], v10 offset:28672
  v_mfma_f32_32x32x16_bf16 v[160:175], v[104:107], v[92:95], v[160:175]
  ds_read_b64_tr_b16 v[86:87], v10 offset:29184
  ds_read_b128 v[68:71], v4 offset:36864
  v_mfma_f32_32x32x16_bf16 v[176:191], v[108:111], v[92:95], v[176:191]
  ds_read_b128 v[72:75], v4 offset:40960
  ds_read_b128 v[76:79], v4 offset:45056
  v_mfma_f32_32x32x16_bf16 v[192:207], v[104:107], v[96:99], v[192:207]
  s_add_u32 m0, s25, 2048
  s_nop 0
  buffer_load_dwordx4 v13, s[72:75], s36 offen lds
  v_mfma_f32_32x32x16_bf16 v[208:223], v[108:111], v[96:99], v[208:223]
  s_add_u32 m0, s24, 4096
  s_nop 0
  buffer_load_dwordx4 v11, s[4:7], s30 offen lds
  v_mfma_f32_32x32x16_bf16 v[224:239], v[104:107], v[100:103], v[224:239]
  s_add_u32 m0, s24, 5120
  s_nop 0
  buffer_load_dwordx4 v12, s[4:7], s31 offen lds
  v_mfma_f32_32x32x16_bf16 v[240:255], v[108:111], v[100:103], v[240:255]
  s_waitcnt lgkmcnt(0)
  v_mfma_f32_32x32x16_bf16 v[128:143], v[80:83], v[64:67], v[128:143]
  ds_read_b64_tr_b16 v[104:105], v10 offset:22528
  ds_read_b64_tr_b16 v[106:107], v10 offset:23040
  v_mfma_f32_32x32x16_bf16 v[144:159], v[84:87], v[64:67], v[144:159]
  ds_read_b128 v[88:91], v5 offset:32768
  ds_read_b64_tr_b16 v[108:109], v10 offset:30720
  v_mfma_f32_32x32x16_bf16 v[160:175], v[80:83], v[68:71], v[160:175]
  ds_read_b64_tr_b16 v[110:111], v10 offset:31232
  ds_read_b128 v[92:95], v5 offset:36864
  v_mfma_f32_32x32x16_bf16 v[176:191], v[84:87], v[68:71], v[176:191]
  ds_read_b128 v[96:99], v5 offset:40960
  ds_read_b128 v[100:103], v5 offset:45056
  v_mfma_f32_32x32x16_bf16 v[192:207], v[80:83], v[72:75], v[192:207]
  s_add_u32 m0, s25, 3072
  s_nop 0
  buffer_load_dwordx4 v13, s[72:75], s37 offen lds
  v_mfma_f32_32x32x16_bf16 v[208:223], v[84:87], v[72:75], v[208:223]
  s_add_u32 m0, s24, 6144
  s_nop 0
  buffer_load_dwordx4 v11, s[4:7], s32 offen lds
  v_mfma_f32_32x32x16_bf16 v[224:239], v[80:83], v[76:79], v[224:239]
  s_add_u32 m0, s24, 7168
  s_nop 0
  buffer_load_dwordx4 v12, s[4:7], s33 offen lds
  v_mfma_f32_32x32x16_bf16 v[240:255], v[84:87], v[76:79], v[240:255]
  s_add_u32 s4, s4, 128
  s_addc_u32 s5, s5, 0
  s_add_u32 s72, s72, s38
  s_addc_u32 s73, s73, 0
  s_waitcnt lgkmcnt(0)
  s_waitcnt vmcnt(12)
  s_barrier
  v_mfma_f32_32x32x16_bf16 v[128:143], v[104:107], v[88:91], v[128:143]
  ds_read_b64_tr_b16 v[80:81], v10 offset:32768
  ds_read_b64_tr_b16 v[82:83], v10 offset:33280
  v_mfma_f32_32x32x16_bf16 v[144:159], v[108:111], v[88:91], v[144:159]
  ds_read_b128 v[64:67], v6 offset:0
  ds_read_b64_tr_b16 v[84:85], v10 offset:40960
  v_mfma_f32_32x32x16_bf16 v[160:175], v[104:107], v[92:95], v[160:175]
  ds_read_b64_tr_b16 v[86:87], v10 offset:41472
  ds_read_b128 v[68:71], v6 offset:4096
  v_mfma_f32_32x32x16_bf16 v[176:191], v[108:111], v[92:95], v[176:191]
  ds_read_b128 v[72:75], v6 offset:8192
  ds_read_b128 v[76:79], v6 offset:12288
  v_mfma_f32_32x32x16_bf16 v[192:207], v[104:107], v[96:99], v[192:207]
  s_add_u32 m0, s25, 16384
  s_nop 0
  buffer_load_dwordx4 v13, s[72:75], s34 offen lds
  v_mfma_f32_32x32x16_bf16 v[208:223], v[108:111], v[96:99], v[208:223]
  s_add_u32 m0, s24, 32768
  s_nop 0
  buffer_load_dwordx4 v11, s[4:7], s26 offen lds
  v_mfma_f32_32x32x16_bf16 v[224:239], v[104:107], v[100:103], v[224:239]
  s_add_u32 m0, s24, 33792
  s_nop 0
  buffer_load_dwordx4 v12, s[4:7], s27 offen lds
  v_mfma_f32_32x32x16_bf16 v[240:255], v[108:111], v[100:103], v[240:255]
  s_waitcnt lgkmcnt(0)
  v_mfma_f32_32x32x16_bf16 v[128:143], v[80:83], v[64:67], v[128:143]
  ds_read_b64_tr_b16 v[104:105], v10 offset:34816
  ds_read_b64_tr_b16 v[106:107], v10 offset:35328
  v_mfma_f32_32x32x16_bf16 v[144:159], v[84:87], v[64:67], v[144:159]
  ds_read_b128 v[88:91], v7 offset:0
  ds_read_b64_tr_b16 v[108:109], v10 offset:43008
  v_mfma_f32_32x32x16_bf16 v[160:175], v[80:83], v[68:71], v[160:175]
  ds_read_b64_tr_b16 v[110:111], v10 offset:43520
  ds_read_b128 v[92:95], v7 offset:4096
  v_mfma_f32_32x32x16_bf16 v[176:191], v[84:87], v[68:71], v[176:191]
  ds_read_b128 v[96:99], v7 offset:8192
  ds_read_b128 v[100:103], v7 offset:12288
  v_mfma_f32_32x32x16_bf16 v[192:207], v[80:83], v[72:75], v[192:207]
  s_add_u32 m0, s25, 17408
  s_nop 0
  buffer_load_dwordx4 v13, s[72:75], s35 offen lds
  v_mfma_f32_32x32x16_bf16 v[208:223], v[84:87], v[72:75], v[208:223]
  s_add_u32 m0, s24, 34816
  s_nop 0
  buffer_load_dwordx4 v11, s[4:7], s28 offen lds
  v_mfma_f32_32x32x16_bf16 v[224:239], v[80:83], v[76:79], v[224:239]
  s_add_u32 m0, s24, 35840
  s_nop 0
  buffer_load_dwordx4 v12, s[4:7], s29 offen lds
  v_mfma_f32_32x32x16_bf16 v[240:255], v[84:87], v[76:79], v[240:255]
  s_waitcnt lgkmcnt(0)
  v_mfma_f32_32x32x16_bf16 v[128:143], v[104:107], v[88:91], v[128:143]
  ds_read_b64_tr_b16 v[80:81], v10 offset:36864
  ds_read_b64_tr_b16 v[82:83], v10 offset:37376
  v_mfma_f32_32x32x16_bf16 v[144:159], v[108:111], v[88:91], v[144:159]
  ds_read_b128 v[64:67], v8 offset:0
  ds_read_b64_tr_b16 v[84:85], v10 offset:45056
  v_mfma_f32_32x32x16_bf16 v[160:175], v[104:107], v[92:95], v[160:175]
  ds_read_b64_tr_b16 v[86:87], v10 offset:45568
  ds_read_b128 v[68:71], v8 offset:4096
  v_mfma_f32_32x32x16_bf16 v[176:191], v[108:111], v[92:95], v[176:191]
  ds_read_b128 v[72:75], v8 offset:8192
  ds_read_b128 v[76:79], v8 offset:12288
  v_mfma_f32_32x32x16_bf16 v[192:207], v[104:107], v[96:99], v[192:207]
  s_add_u32 m0, s25, 18432
  s_nop 0
  buffer_load_dwordx4 v13, s[72:75], s36 offen lds
  v_mfma_f32_32x32x16_bf16 v[208:223], v[108:111], v[96:99], v[208:223]
  s_add_u32 m0, s24, 36864
  s_nop 0
  buffer_load_dwordx4 v11, s[4:7], s30 offen lds
  v_mfma_f32_32x32x16_bf16 v[224:239], v[104:107], v[100:103], v[224:239]
  s_add_u32 m0, s24, 37888
  s_nop 0
  buffer_load_dwordx4 v12, s[4:7], s31 offen lds
  v_mfma_f32_32x32x16_bf16 v[240:255], v[108:111], v[100:103], v[240:255]
  s_waitcnt lgkmcnt(0)
  v_mfma_f32_32x32x16_bf16 v[128:143], v[80:83], v[64:67], v[128:143]
  ds_read_b64_tr_b16 v[104:105], v10 offset:38912
  ds_read_b64_tr_b16 v[106:107], v10 offset:39424
  v_mfma_f32_32x32x16_bf16 v[144:159], v[84:87], v[64:67], v[144:159]
  ds_read_b128 v[88:91], v9 offset:0
  ds_read_b64_tr_b16 v[108:109], v10 offset:47104
  v_mfma_f32_32x32x16_bf16 v[160:175], v[80:83], v[68:71], v[160:175]
  ds_read_b64_tr_b16 v[110:111], v10 offset:47616
  ds_read_b128 v[92:95], v9 offset:4096
  v_mfma_f32_32x32x16_bf16 v[176:191], v[84:87], v[68:71], v[176:191]
  ds_read_b128 v[96:99], v9 offset:8192
  ds_read_b128 v[100:103], v9 offset:12288
  v_mfma_f32_32x32x16_bf16 v[192:207], v[80:83], v[72:75], v[192:207]
  s_add_u32 m0, s25, 19456
  s_nop 0
  buffer_load_dwordx4 v13, s[72:75], s37 offen lds
  v_mfma_f32_32x32x16_bf16 v[208:223], v[84:87], v[72:75], v[208:223]
  s_add_u32 m0, s24, 38912
  s_nop 0
  buffer_load_dwordx4 v11, s[4:7], s32 offen lds
  v_mfma_f32_32x32x16_bf16 v[224:239], v[80:83], v[76:79], v[224:239]
  s_add_u32 m0, s24, 39936
  s_nop 0
  buffer_load_dwordx4 v12, s[4:7], s33 offen lds
  v_mfma_f32_32x32x16_bf16 v[240:255], v[84:87], v[76:79], v[240:255]
  s_add_u32 s4, s4, 128
  s_addc_u32 s5, s5, 0
  s_add_u32 s72, s72, s38
  s_addc_u32 s73, s73, 0
  s_waitcnt lgkmcnt(0)
  s_waitcnt vmcnt(12)
  s_barrier
  v_mfma_f32_32x32x16_bf16 v[128:143], v[104:107], v[88:91], v[128:143]
  ds_read_b64_tr_b16 v[80:81], v10 offset:0
  ds_read_b64_tr_b16 v[82:83], v10 offset:512
  v_mfma_f32_32x32x16_bf16 v[144:159], v[108:111], v[88:91], v[144:159]
  ds_read_b128 v[64:67], v2 offset:0
  ds_read_b64_tr_b16 v[84:85], v10 offset:8192
  v_mfma_f32_32x32x16_bf16 v[160:175], v[104:107], v[92:95], v[160:175]
  ds_read_b64_tr_b16 v[86:87], v10 offset:8704
  ds_read_b128 v[68:71], v2 offset:4096
  v_mfma_f32_32x32x16_bf16 v[176:191], v[108:111], v[92:95], v[176:191]
  ds_read_b128 v[72:75], v2 offset:8192
  ds_read_b128 v[76:79], v2 offset:12288
  v_mfma_f32_32x32x16_bf16 v[192:207], v[104:107], v[96:99], v[192:207]
  s_add_u32 m0, s25, 32768
  s_nop 0
  buffer_load_dwordx4 v13, s[72:75], s34 offen lds
  v_mfma_f32_32x32x16_bf16 v[208:223], v[108:111], v[96:99], v[208:223]
  s_add_u32 m0, s24, 65536
  s_nop 0
  buffer_load_dwordx4 v11, s[4:7], s26 offen lds
  v_mfma_f32_32x32x16_bf16 v[224:239], v[104:107], v[100:103], v[224:239]
  s_add_u32 m0, s24, 66560
  s_nop 0
  buffer_load_dwordx4 v12, s[4:7], s27 offen lds
  v_mfma_f32_32x32x16_bf16 v[240:255], v[108:111], v[100:103], v[240:255]
  s_waitcnt lgkmcnt(0)
  v_mfma_f32_32x32x16_bf16 v[128:143], v[80:83], v[64:67], v[128:143]
  ds_read_b64_tr_b16 v[104:105], v10 offset:2048
  ds_read_b64_tr_b16 v[106:107], v10 offset:2560
  v_mfma_f32_32x32x16_bf16 v[144:159], v[84:87], v[64:67], v[144:159]
  ds_read_b128 v[88:91], v3 offset:0
  ds_read_b64_tr_b16 v[108:109], v10 offset:10240
  v_mfma_f32_32x32x16_bf16 v[160:175], v[80:83], v[68:71], v[160:175]
  ds_read_b64_tr_b16 v[110:111], v10 offset:10752
  ds_read_b128 v[92:95], v3 offset:4096
  v_mfma_f32_32x32x16_bf16 v[176:191], v[84:87], v[68:71], v[176:191]
  ds_read_b128 v[96:99], v3 offset:8192
  ds_read_b128 v[100:103], v3 offset:12288
  v_mfma_f32_32x32x16_bf16 v[192:207], v[80:83], v[72:75], v[192:207]
  s_add_u32 m0, s25, 33792
  s_nop 0
  buffer_load_dwordx4 v13, s[72:75], s35 offen lds
  v_mfma_f32_32x32x16_bf16 v[208:223], v[84:87], v[72:75], v[208:223]
  s_add_u32 m0, s24, 67584
  s_nop 0
  buffer_load_dwordx4 v11, s[4:7], s28 offen lds
  v_mfma_f32_32x32x16_bf16 v[224:239], v[80:83], v[76:79], v[224:239]
  s_add_u32 m0, s24, 68608
  s_nop 0
  buffer_load_dwordx4 v12, s[4:7], s29 offen lds
  v_mfma_f32_32x32x16_bf16 v[240:255], v[84:87], v[76:79], v[240:255]
  s_waitcnt lgkmcnt(0)
  v_mfma_f32_32x32x16_bf16 v[128:143], v[104:107], v[88:91], v[128:143]
  ds_read_b64_tr_b16 v[80:81], v10 offset:4096
  ds_read_b64_tr_b16 v[82:83], v10 offset:4608
  v_mfma_f32_32x32x16_bf16 v[144:159], v[108:111], v[88:91], v[144:159]
  ds_read_b128 v[64:67], v4 offset:0
  ds_read_b64_tr_b16 v[84:85], v10 offset:12288
  v_mfma_f32_32x32x16_bf16 v[160:175], v[104:107], v[92:95], v[160:175]
  ds_read_b64_tr_b16 v[86:87], v10 offset:12800
  ds_read_b128 v[68:71], v4 offset:4096
  v_mfma_f32_32x32x16_bf16 v[176:191], v[108:111], v[92:95], v[176:191]
  ds_read_b128 v[72:75], v4 offset:8192
  ds_read_b128 v[76:79], v4 offset:12288
  v_mfma_f32_32x32x16_bf16 v[192:207], v[104:107], v[96:99], v[192:207]
  s_add_u32 m0, s25, 34816
  s_nop 0
  buffer_load_dwordx4 v13, s[72:75], s36 offen lds
  v_mfma_f32_32x32x16_bf16 v[208:223], v[108:111], v[96:99], v[208:223]
  s_add_u32 m0, s24, 69632
  s_nop 0
  buffer_load_dwordx4 v11, s[4:7], s30 offen lds
  v_mfma_f32_32x32x16_bf16 v[224:239], v[104:107], v[100:103], v[224:239]
  s_add_u32 m0, s24, 70656
  s_nop 0
  buffer_load_dwordx4 v12, s[4:7], s31 offen lds
  v_mfma_f32_32x32x16_bf16 v[240:255], v[108:111], v[100:103], v[240:255]
  s_waitcnt lgkmcnt(0)
  v_mfma_f32_32x32x16_bf16 v[128:143], v[80:83], v[64:67], v[128:143]
  ds_read_b64_tr_b16 v[104:105], v10 offset:6144
  ds_read_b64_tr_b16 v[106:107], v10 offset:6656
  v_mfma_f32_32x32x16_bf16 v[144:159], v[84:87], v[64:67], v[144:159]
  ds_read_b128 v[88:91], v5 offset:0
  ds_read_b64_tr_b16 v[108:109], v10 offset:14336
  v_mfma_f32_32x32x16_bf16 v[160:175], v[80:83], v[68:71], v[160:175]
  ds_read_b64_tr_b16 v[110:111], v10 offset:14848
  ds_read_b128 v[92:95], v5 offset:4096
  v_mfma_f32_32x32x16_bf16 v[176:191], v[84:87], v[68:71], v[176:191]
  ds_read_b128 v[96:99], v5 offset:8192
  ds_read_b128 v[100:103], v5 offset:12288
  v_mfma_f32_32x32x16_bf16 v[192:207], v[80:83], v[72:75], v[192:207]
  s_add_u32 m0, s25, 35840
  s_nop 0
  buffer_load_dwordx4 v13, s[72:75], s37 offen lds
  v_mfma_f32_32x32x16_bf16 v[208:223], v[84:87], v[72:75], v[208:223]
  s_add_u32 m0, s24, 71680
  s_nop 0
  buffer_load_dwordx4 v11, s[4:7], s32 offen lds
  v_mfma_f32_32x32x16_bf16 v[224:239], v[80:83], v[76:79], v[224:239]
  s_add_u32 m0, s24, 72704
  s_nop 0
  buffer_load_dwordx4 v12, s[4:7], s33 offen lds
  v_mfma_f32_32x32x16_bf16 v[240:255], v[84:87], v[76:79], v[240:255]
  s_add_u32 s4, s4, 128
  s_addc_u32 s5, s5, 0
  s_add_u32 s72, s72, s38
  s_addc_u32 s73, s73, 0
  s_waitcnt lgkmcnt(0)
  s_waitcnt vmcnt(12)
  s_barrier
  v_mfma_f32_32x32x16_bf16 v[128:143], v[104:107], v[88:91], v[128:143]
  ds_read_b64_tr_b16 v[80:81], v10 offset:16384
  ds_read_b64_tr_b16 v[82:83], v10 offset:16896
  v_mfma_f32_32x32x16_bf16 v[144:159], v[108:111], v[88:91], v[144:159]
  ds_read_b128 v[64:67], v2 offset:32768
  ds_read_b64_tr_b16 v[84:85], v10 offset:24576
  v_mfma_f32_32x32x16_bf16 v[160:175], v[104:107], v[92:95], v[160:175]
  ds_read_b64_tr_b16 v[86:87], v10 offset:25088
  ds_read_b128 v[68:71], v2 offset:36864
  v_mfma_f32_32x32x16_bf16 v[176:191], v[108:111], v[92:95], v[176:191]
  ds_read_b128 v[72:75], v2 offset:40960
  ds_read_b128 v[76:79], v2 offset:45056
  v_mfma_f32_32x32x16_bf16 v[192:207], v[104:107], v[96:99], v[192:207]
  s_add_u32 m0, s25, 0
  s_nop 0
  buffer_load_dwordx4 v13, s[72:75], s34 offen lds
  v_mfma_f32_32x32x16_bf16 v[208:223], v[108:111], v[96:99], v[208:223]
  s_add_u32 m0, s24, 0
  s_nop 0
  buffer_load_dwordx4 v11, s[4:7], s26 offen lds
  v_mfma_f32_32x32x16_bf16 v[224:239], v[104:107], v[100:103], v[224:239]
  s_add_u32 m0, s24, 1024
  s_nop 0
  buffer_load_dwordx4 v12, s[4:7], s27 offen lds
  v_mfma_f32_32x32x16_bf16 v[240:255], v[108:111], v[100:103], v[240:255]
  s_waitcnt lgkmcnt(0)
  v_mfma_f32_32x32x16_bf16 v[128:143], v[80:83], v[64:67], v[128:143]
  ds_read_b64_tr_b16 v[104:105], v10 offset:18432
  ds_read_b64_tr_b16 v[106:107], v10 offset:18944
  v_mfma_f32_32x32x16_bf16 v[144:159], v[84:87], v[64:67], v[144:159]
  ds_read_b128 v[88:91], v3 offset:32768
  ds_read_b64_tr_b16 v[108:109], v10 offset:26624
  v_mfma_f32_32x32x16_bf16 v[160:175], v[80:83], v[68:71], v[160:175]
  ds_read_b64_tr_b16 v[110:111], v10 offset:27136
  ds_read_b128 v[92:95], v3 offset:36864
  v_mfma_f32_32x32x16_bf16 v[176:191], v[84:87], v[68:71], v[176:191]
  ds_read_b128 v[96:99], v3 offset:40960
  ds_read_b128 v[100:103], v3 offset:45056
  v_mfma_f32_32x32x16_bf16 v[192:207], v[80:83], v[72:75], v[192:207]
  s_add_u32 m0, s25, 1024
  s_nop 0
  buffer_load_dwordx4 v13, s[72:75], s35 offen lds
  v_mfma_f32_32x32x16_bf16 v[208:223], v[84:87], v[72:75], v[208:223]
  s_add_u32 m0, s24, 2048
  s_nop 0
  buffer_load_dwordx4 v11, s[4:7], s28 offen lds
  v_mfma_f32_32x32x16_bf16 v[224:239], v[80:83], v[76:79], v[224:239]
  s_add_u32 m0, s24, 3072
  s_nop 0
  buffer_load_dwordx4 v12, s[4:7], s29 offen lds
  v_mfma_f32_32x32x16_bf16 v[240:255], v[84:87], v[76:79], v[240:255]
  s_waitcnt lgkmcnt(0)
  v_mfma_f32_32x32x16_bf16 v[128:143], v[104:107], v[88:91], v[128:143]
  ds_read_b64_tr_b16 v[80:81], v10 offset:20480
  ds_read_b64_tr_b16 v[82:83], v10 offset:20992
  v_mfma_f32_32x32x16_bf16 v[144:159], v[108:111], v[88:91], v[144:159]
  ds_read_b128 v[64:67], v4 offset:32768
  ds_read_b64_tr_b16 v[84:85], v10 offset:28672
  v_mfma_f32_32x32x16_bf16 v[160:175], v[104:107], v[92:95], v[160:175]
  ds_read_b64_tr_b16 v[86:87], v10 offset:29184
  ds_read_b128 v[68:71], v4 offset:36864
  v_mfma_f32_32x32x16_bf16 v[176:191], v[108:111], v[92:95], v[176:191]
  ds_read_b128 v[72:75], v4 offset:40960
  ds_read_b128 v[76:79], v4 offset:45056
  v_mfma_f32_32x32x16_bf16 v[192:207], v[104:107], v[96:99], v[192:207]
  s_add_u32 m0, s25, 2048
  s_nop 0
  buffer_load_dwordx4 v13, s[72:75], s36 offen lds
  v_mfma_f32_32x32x16_bf16 v[208:223], v[108:111], v[96:99], v[208:223]
  s_add_u32 m0, s24, 4096
  s_nop 0
  buffer_load_dwordx4 v11, s[4:7], s30 offen lds
  v_mfma_f32_32x32x16_bf16 v[224:239], v[104:107], v[100:103], v[224:239]
  s_add_u32 m0, s24, 5120
  s_nop 0
  buffer_load_dwordx4 v12, s[4:7], s31 offen lds
  v_mfma_f32_32x32x16_bf16 v[240:255], v[108:111], v[100:103], v[240:255]
  s_waitcnt lgkmcnt(0)
  v_mfma_f32_32x32x16_bf16 v[128:143], v[80:83], v[64:67], v[128:143]
  ds_read_b64_tr_b16 v[104:105], v10 offset:22528
  ds_read_b64_tr_b16 v[106:107], v10 offset:23040
  v_mfma_f32_32x32x16_bf16 v[144:159], v[84:87], v[64:67], v[144:159]
  ds_read_b128 v[88:91], v5 offset:32768
  ds_read_b64_tr_b16 v[108:109], v10 offset:30720
  v_mfma_f32_32x32x16_bf16 v[160:175], v[80:83], v[68:71], v[160:175]
  ds_read_b64_tr_b16 v[110:111], v10 offset:31232
  ds_read_b128 v[92:95], v5 offset:36864
  v_mfma_f32_32x32x16_bf16 v[176:191], v[84:87], v[68:71], v[176:191]
  ds_read_b128 v[96:99], v5 offset:40960
  ds_read_b128 v[100:103], v5 offset:45056
  v_mfma_f32_32x32x16_bf16 v[192:207], v[80:83], v[72:75], v[192:207]
  s_add_u32 m0, s25, 3072
  s_nop 0
  buffer_load_dwordx4 v13, s[72:75], s37 offen lds
  v_mfma_f32_32x32x16_bf16 v[208:223], v[84:87], v[72:75], v[208:223]
  s_add_u32 m0, s24, 6144
  s_nop 0
  buffer_load_dwordx4 v11, s[4:7], s32 offen lds
  v_mfma_f32_32x32x16_bf16 v[224:239], v[80:83], v[76:79], v[224:239]
  s_add_u32 m0, s24, 7168
  s_nop 0
  buffer_load_dwordx4 v12, s[4:7], s33 offen lds
  v_mfma_f32_32x32x16_bf16 v[240:255], v[84:87], v[76:79], v[240:255]
  s_add_u32 s4, s4, 128
  s_addc_u32 s5, s5, 0
  s_add_u32 s72, s72, s38
  s_addc_u32 s73, s73, 0
  s_waitcnt lgkmcnt(0)
  s_waitcnt vmcnt(12)
  s_barrier
  v_mfma_f32_32x32x16_bf16 v[128:143], v[104:107], v[88:91], v[128:143]
  ds_read_b64_tr_b16 v[80:81], v10 offset:32768
  ds_read_b64_tr_b16 v[82:83], v10 offset:33280
  v_mfma_f32_32x32x16_bf16 v[144:159], v[108:111], v[88:91], v[144:159]
  ds_read_b128 v[64:67], v6 offset:0
  ds_read_b64_tr_b16 v[84:85], v10 offset:40960
  v_mfma_f32_32x32x16_bf16 v[160:175], v[104:107], v[92:95], v[160:175]
  ds_read_b64_tr_b16 v[86:87], v10 offset:41472
  ds_read_b128 v[68:71], v6 offset:4096
  v_mfma_f32_32x32x16_bf16 v[176:191], v[108:111], v[92:95], v[176:191]
  ds_read_b128 v[72:75], v6 offset:8192
  ds_read_b128 v[76:79], v6 offset:12288
  v_mfma_f32_32x32x16_bf16 v[192:207], v[104:107], v[96:99], v[192:207]
  s_add_u32 m0, s25, 16384
  s_nop 0
  buffer_load_dwordx4 v13, s[72:75], s34 offen lds
  v_mfma_f32_32x32x16_bf16 v[208:223], v[108:111], v[96:99], v[208:223]
  s_add_u32 m0, s24, 32768
  s_nop 0
  buffer_load_dwordx4 v11, s[4:7], s26 offen lds
  v_mfma_f32_32x32x16_bf16 v[224:239], v[104:107], v[100:103], v[224:239]
  s_add_u32 m0, s24, 33792
  s_nop 0
  buffer_load_dwordx4 v12, s[4:7], s27 offen lds
  v_mfma_f32_32x32x16_bf16 v[240:255], v[108:111], v[100:103], v[240:255]
  s_waitcnt lgkmcnt(0)
  v_mfma_f32_32x32x16_bf16 v[128:143], v[80:83], v[64:67], v[128:143]
  ds_read_b64_tr_b16 v[104:105], v10 offset:34816
  ds_read_b64_tr_b16 v[106:107], v10 offset:35328
  v_mfma_f32_32x32x16_bf16 v[144:159], v[84:87], v[64:67], v[144:159]
  ds_read_b128 v[88:91], v7 offset:0
  ds_read_b64_tr_b16 v[108:109], v10 offset:43008
  v_mfma_f32_32x32x16_bf16 v[160:175], v[80:83], v[68:71], v[160:175]
  ds_read_b64_tr_b16 v[110:111], v10 offset:43520
  ds_read_b128 v[92:95], v7 offset:4096
  v_mfma_f32_32x32x16_bf16 v[176:191], v[84:87], v[68:71], v[176:191]
  ds_read_b128 v[96:99], v7 offset:8192
  ds_read_b128 v[100:103], v7 offset:12288
  v_mfma_f32_32x32x16_bf16 v[192:207], v[80:83], v[72:75], v[192:207]
  s_add_u32 m0, s25, 17408
  s_nop 0
  buffer_load_dwordx4 v13, s[72:75], s35 offen lds
  v_mfma_f32_32x32x16_bf16 v[208:223], v[84:87], v[72:75], v[208:223]
  s_add_u32 m0, s24, 34816
  s_nop 0
  buffer_load_dwordx4 v11, s[4:7], s28 offen lds
  v_mfma_f32_32x32x16_bf16 v[224:239], v[80:83], v[76:79], v[224:239]
  s_add_u32 m0, s24, 35840
  s_nop 0
  buffer_load_dwordx4 v12, s[4:7], s29 offen lds
  v_mfma_f32_32x32x16_bf16 v[240:255], v[84:87], v[76:79], v[240:255]
  s_waitcnt lgkmcnt(0)
  v_mfma_f32_32x32x16_bf16 v[128:143], v[104:107], v[88:91], v[128:143]
  ds_read_b64_tr_b16 v[80:81], v10 offset:36864
  ds_read_b64_tr_b16 v[82:83], v10 offset:37376
  v_mfma_f32_32x32x16_bf16 v[144:159], v[108:111], v[88:91], v[144:159]
  ds_read_b128 v[64:67], v8 offset:0
  ds_read_b64_tr_b16 v[84:85], v10 offset:45056
  v_mfma_f32_32x32x16_bf16 v[160:175], v[104:107], v[92:95], v[160:175]
  ds_read_b64_tr_b16 v[86:87], v10 offset:45568
  ds_read_b128 v[68:71], v8 offset:4096
  v_mfma_f32_32x32x16_bf16 v[176:191], v[108:111], v[92:95], v[176:191]
  ds_read_b128 v[72:75], v8 offset:8192
  ds_read_b128 v[76:79], v8 offset:12288
  v_mfma_f32_32x32x16_bf16 v[192:207], v[104:107], v[96:99], v[192:207]
  s_add_u32 m0, s25, 18432
  s_nop 0
  buffer_load_dwordx4 v13, s[72:75], s36 offen lds
  v_mfma_f32_32x32x16_bf16 v[208:223], v[108:111], v[96:99], v[208:223]
  s_add_u32 m0, s24, 36864
  s_nop 0
  buffer_load_dwordx4 v11, s[4:7], s30 offen lds
  v_mfma_f32_32x32x16_bf16 v[224:239], v[104:107], v[100:103], v[224:239]
  s_add_u32 m0, s24, 37888
  s_nop 0
  buffer_load_dwordx4 v12, s[4:7], s31 offen lds
  v_mfma_f32_32x32x16_bf16 v[240:255], v[108:111], v[100:103], v[240:255]
  s_waitcnt lgkmcnt(0)
  v_mfma_f32_32x32x16_bf16 v[128:143], v[80:83], v[64:67], v[128:143]
  ds_read_b64_tr_b16 v[104:105], v10 offset:38912
  ds_read_b64_tr_b16 v[106:107], v10 offset:39424
  v_mfma_f32_32x32x16_bf16 v[144:159], v[84:87], v[64:67], v[144:159]
  ds_read_b128 v[88:91], v9 offset:0
  ds_read_b64_tr_b16 v[108:109], v10 offset:47104
  v_mfma_f32_32x32x16_bf16 v[160:175], v[80:83], v[68:71], v[160:175]
  ds_read_b64_tr_b16 v[110:111], v10 offset:47616
  ds_read_b128 v[92:95], v9 offset:4096
  v_mfma_f32_32x32x16_bf16 v[176:191], v[84:87], v[68:71], v[176:191]
  ds_read_b128 v[96:99], v9 offset:8192
  ds_read_b128 v[100:103], v9 offset:12288
  v_mfma_f32_32x32x16_bf16 v[192:207], v[80:83], v[72:75], v[192:207]
  s_add_u32 m0, s25, 19456
  s_nop 0
  buffer_load_dwordx4 v13, s[72:75], s37 offen lds
  v_mfma_f32_32x32x16_bf16 v[208:223], v[84:87], v[72:75], v[208:223]
  s_add_u32 m0, s24, 38912
  s_nop 0
  buffer_load_dwordx4 v11, s[4:7], s32 offen lds
  v_mfma_f32_32x32x16_bf16 v[224:239], v[80:83], v[76:79], v[224:239]
  s_add_u32 m0, s24, 39936
  s_nop 0
  buffer_load_dwordx4 v12, s[4:7], s33 offen lds
  v_mfma_f32_32x32x16_bf16 v[240:255], v[84:87], v[76:79], v[240:255]
  s_add_u32 s4, s4, 128
  s_addc_u32 s5, s5, 0
  s_add_u32 s72, s72, s38
  s_addc_u32 s73, s73, 0
  s_waitcnt lgkmcnt(0)
  s_waitcnt vmcnt(12)
  s_barrier
  v_mfma_f32_32x32x16_bf16 v[128:143], v[104:107], v[88:91], v[128:143]
  ds_read_b64_tr_b16 v[80:81], v10 offset:0
  ds_read_b64_tr_b16 v[82:83], v10 offset:512
  v_mfma_f32_32x32x16_bf16 v[144:159], v[108:111], v[88:91], v[144:159]
  ds_read_b128 v[64:67], v2 offset:0
  ds_read_b64_tr_b16 v[84:85], v10 offset:8192
  v_mfma_f32_32x32x16_bf16 v[160:175], v[104:107], v[92:95], v[160:175]
  ds_read_b64_tr_b16 v[86:87], v10 offset:8704
  ds_read_b128 v[68:71], v2 offset:4096
  v_mfma_f32_32x32x16_bf16 v[176:191], v[108:111], v[92:95], v[176:191]
  ds_read_b128 v[72:75], v2 offset:8192
  ds_read_b128 v[76:79], v2 offset:12288
  v_mfma_f32_32x32x16_bf16 v[192:207], v[104:107], v[96:99], v[192:207]
  s_add_u32 m0, s25, 32768
  s_nop 0
  buffer_load_dwordx4 v13, s[72:75], s34 offen lds
  v_mfma_f32_32x32x16_bf16 v[208:223], v[108:111], v[96:99], v[208:223]
  s_add_u32 m0, s24, 65536
  s_nop 0
  buffer_load_dwordx4 v11, s[4:7], s26 offen lds
  v_mfma_f32_32x32x16_bf16 v[224:239], v[104:107], v[100:103], v[224:239]
  s_add_u32 m0, s24, 66560
  s_nop 0
  buffer_load_dwordx4 v12, s[4:7], s27 offen lds
  v_mfma_f32_32x32x16_bf16 v[240:255], v[108:111], v[100:103], v[240:255]
  s_waitcnt lgkmcnt(0)
  v_mfma_f32_32x32x16_bf16 v[128:143], v[80:83], v[64:67], v[128:143]
  ds_read_b64_tr_b16 v[104:105], v10 offset:2048
  ds_read_b64_tr_b16 v[106:107], v10 offset:2560
  v_mfma_f32_32x32x16_bf16 v[144:159], v[84:87], v[64:67], v[144:159]
  ds_read_b128 v[88:91], v3 offset:0
  ds_read_b64_tr_b16 v[108:109], v10 offset:10240
  v_mfma_f32_32x32x16_bf16 v[160:175], v[80:83], v[68:71], v[160:175]
  ds_read_b64_tr_b16 v[110:111], v10 offset:10752
  ds_read_b128 v[92:95], v3 offset:4096
  v_mfma_f32_32x32x16_bf16 v[176:191], v[84:87], v[68:71], v[176:191]
  ds_read_b128 v[96:99], v3 offset:8192
  ds_read_b128 v[100:103], v3 offset:12288
  v_mfma_f32_32x32x16_bf16 v[192:207], v[80:83], v[72:75], v[192:207]
  s_add_u32 m0, s25, 33792
  s_nop 0
  buffer_load_dwordx4 v13, s[72:75], s35 offen lds
  v_mfma_f32_32x32x16_bf16 v[208:223], v[84:87], v[72:75], v[208:223]
  s_add_u32 m0, s24, 67584
  s_nop 0
  buffer_load_dwordx4 v11, s[4:7], s28 offen lds
  v_mfma_f32_32x32x16_bf16 v[224:239], v[80:83], v[76:79], v[224:239]
  s_add_u32 m0, s24, 68608
  s_nop 0
  buffer_load_dwordx4 v12, s[4:7], s29 offen lds
  v_mfma_f32_32x32x16_bf16 v[240:255], v[84:87], v[76:79], v[240:255]
  s_waitcnt lgkmcnt(0)
  v_mfma_f32_32x32x16_bf16 v[128:143], v[104:107], v[88:91], v[128:143]
  ds_read_b64_tr_b16 v[80:81], v10 offset:4096
  ds_read_b64_tr_b16 v[82:83], v10 offset:4608
  v_mfma_f32_32x32x16_bf16 v[144:159], v[108:111], v[88:91], v[144:159]
  ds_read_b128 v[64:67], v4 offset:0
  ds_read_b64_tr_b16 v[84:85], v10 offset:12288
  v_mfma_f32_32x32x16_bf16 v[160:175], v[104:107], v[92:95], v[160:175]
  ds_read_b64_tr_b16 v[86:87], v10 offset:12800
  ds_read_b128 v[68:71], v4 offset:4096
  v_mfma_f32_32x32x16_bf16 v[176:191], v[108:111], v[92:95], v[176:191]
  ds_read_b128 v[72:75], v4 offset:8192
  ds_read_b128 v[76:79], v4 offset:12288
  v_mfma_f32_32x32x16_bf16 v[192:207], v[104:107], v[96:99], v[192:207]
  s_add_u32 m0, s25, 34816
  s_nop 0
  buffer_load_dwordx4 v13, s[72:75], s36 offen lds
  v_mfma_f32_32x32x16_bf16 v[208:223], v[108:111], v[96:99], v[208:223]
  s_add_u32 m0, s24, 69632
  s_nop 0
  buffer_load_dwordx4 v11, s[4:7], s30 offen lds
  v_mfma_f32_32x32x16_bf16 v[224:239], v[104:107], v[100:103], v[224:239]
  s_add_u32 m0, s24, 70656
  s_nop 0
  buffer_load_dwordx4 v12, s[4:7], s31 offen lds
  v_mfma_f32_32x32x16_bf16 v[240:255], v[108:111], v[100:103], v[240:255]
  s_waitcnt lgkmcnt(0)
  v_mfma_f32_32x32x16_bf16 v[128:143], v[80:83], v[64:67], v[128:143]
  ds_read_b64_tr_b16 v[104:105], v10 offset:6144
  ds_read_b64_tr_b16 v[106:107], v10 offset:6656
  v_mfma_f32_32x32x16_bf16 v[144:159], v[84:87], v[64:67], v[144:159]
  ds_read_b128 v[88:91], v5 offset:0
  ds_read_b64_tr_b16 v[108:109], v10 offset:14336
  v_mfma_f32_32x32x16_bf16 v[160:175], v[80:83], v[68:71], v[160:175]
  ds_read_b64_tr_b16 v[110:111], v10 offset:14848
  ds_read_b128 v[92:95], v5 offset:4096
  v_mfma_f32_32x32x16_bf16 v[176:191], v[84:87], v[68:71], v[176:191]
  ds_read_b128 v[96:99], v5 offset:8192
  ds_read_b128 v[100:103], v5 offset:12288
  v_mfma_f32_32x32x16_bf16 v[192:207], v[80:83], v[72:75], v[192:207]
  s_add_u32 m0, s25, 35840
  s_nop 0
  buffer_load_dwordx4 v13, s[72:75], s37 offen lds
  v_mfma_f32_32x32x16_bf16 v[208:223], v[84:87], v[72:75], v[208:223]
  s_add_u32 m0, s24, 71680
  s_nop 0
  buffer_load_dwordx4 v11, s[4:7], s32 offen lds
  v_mfma_f32_32x32x16_bf16 v[224:239], v[80:83], v[76:79], v[224:239]
  s_add_u32 m0, s24, 72704
  s_nop 0
  buffer_load_dwordx4 v12, s[4:7], s33 offen lds
  v_mfma_f32_32x32x16_bf16 v[240:255], v[84:87], v[76:79], v[240:255]
  s_add_u32 s4, s4, 128
  s_addc_u32 s5, s5, 0
  s_add_u32 s72, s72, s38
  s_addc_u32 s73, s73, 0
  s_waitcnt lgkmcnt(0)
  s_waitcnt vmcnt(12)
  s_barrier
  v_mfma_f32_32x32x16_bf16 v[128:143], v[104:107], v[88:91], v[128:143]
  ds_read_b64_tr_b16 v[80:81], v10 offset:16384
  ds_read_b64_tr_b16 v[82:83], v10 offset:16896
  v_mfma_f32_32x32x16_bf16 v[144:159], v[108:111], v[88:91], v[144:159]
  ds_read_b128 v[64:67], v2 offset:32768
  ds_read_b64_tr_b16 v[84:85], v10 offset:24576
  v_mfma_f32_32x32x16_bf16 v[160:175], v[104:107], v[92:95], v[160:175]
  ds_read_b64_tr_b16 v[86:87], v10 offset:25088
  ds_read_b128 v[68:71], v2 offset:36864
  v_mfma_f32_32x32x16_bf16 v[176:191], v[108:111], v[92:95], v[176:191]
  ds_read_b128 v[72:75], v2 offset:40960
  ds_read_b128 v[76:79], v2 offset:45056
  v_mfma_f32_32x32x16_bf16 v[192:207], v[104:107], v[96:99], v[192:207]
  s_add_u32 m0, s25, 0
  s_nop 0
  buffer_load_dwordx4 v13, s[72:75], s34 offen lds
  v_mfma_f32_32x32x16_bf16 v[208:223], v[108:111], v[96:99], v[208:223]
  s_add_u32 m0, s24, 0
  s_nop 0
  buffer_load_dwordx4 v11, s[4:7], s26 offen lds
  v_mfma_f32_32x32x16_bf16 v[224:239], v[104:107], v[100:103], v[224:239]
  s_add_u32 m0, s24, 1024
  s_nop 0
  buffer_load_dwordx4 v12, s[4:7], s27 offen lds
  v_mfma_f32_32x32x16_bf16 v[240:255], v[108:111], v[100:103], v[240:255]
  s_waitcnt lgkmcnt(0)
  v_mfma_f32_32x32x16_bf16 v[128:143], v[80:83], v[64:67], v[128:143]
  ds_read_b64_tr_b16 v[104:105], v10 offset:18432
  ds_read_b64_tr_b16 v[106:107], v10 offset:18944
  v_mfma_f32_32x32x16_bf16 v[144:159], v[84:87], v[64:67], v[144:159]
  ds_read_b128 v[88:91], v3 offset:32768
  ds_read_b64_tr_b16 v[108:109], v10 offset:26624
  v_mfma_f32_32x32x16_bf16 v[160:175], v[80:83], v[68:71], v[160:175]
  ds_read_b64_tr_b16 v[110:111], v10 offset:27136
  ds_read_b128 v[92:95], v3 offset:36864
  v_mfma_f32_32x32x16_bf16 v[176:191], v[84:87], v[68:71], v[176:191]
  ds_read_b128 v[96:99], v3 offset:40960
  ds_read_b128 v[100:103], v3 offset:45056
  v_mfma_f32_32x32x16_bf16 v[192:207], v[80:83], v[72:75], v[192:207]
  s_add_u32 m0, s25, 1024
  s_nop 0
  buffer_load_dwordx4 v13, s[72:75], s35 offen lds
  v_mfma_f32_32x32x16_bf16 v[208:223], v[84:87], v[72:75], v[208:223]
  s_add_u32 m0, s24, 2048
  s_nop 0
  buffer_load_dwordx4 v11, s[4:7], s28 offen lds
  v_mfma_f32_32x32x16_bf16 v[224:239], v[80:83], v[76:79], v[224:239]
  s_add_u32 m0, s24, 3072
  s_nop 0
  buffer_load_dwordx4 v12, s[4:7], s29 offen lds
  v_mfma_f32_32x32x16_bf16 v[240:255], v[84:87], v[76:79], v[240:255]
  s_waitcnt lgkmcnt(0)
  v_mfma_f32_32x32x16_bf16 v[128:143], v[104:107], v[88:91], v[128:143]
  ds_read_b64_tr_b16 v[80:81], v10 offset:20480
  ds_read_b64_tr_b16 v[82:83], v10 offset:20992
  v_mfma_f32_32x32x16_bf16 v[144:159], v[108:111], v[88:91], v[144:159]
  ds_read_b128 v[64:67], v4 offset:32768
  ds_read_b64_tr_b16 v[84:85], v10 offset:28672
  v_mfma_f32_32x32x16_bf16 v[160:175], v[104:107], v[92:95], v[160:175]
  ds_read_b64_tr_b16 v[86:87], v10 offset:29184
  ds_read_b128 v[68:71], v4 offset:36864
  v_mfma_f32_32x32x16_bf16 v[176:191], v[108:111], v[92:95], v[176:191]
  ds_read_b128 v[72:75], v4 offset:40960
  ds_read_b128 v[76:79], v4 offset:45056
  v_mfma_f32_32x32x16_bf16 v[192:207], v[104:107], v[96:99], v[192:207]
  s_add_u32 m0, s25, 2048
  s_nop 0
  buffer_load_dwordx4 v13, s[72:75], s36 offen lds
  v_mfma_f32_32x32x16_bf16 v[208:223], v[108:111], v[96:99], v[208:223]
  s_add_u32 m0, s24, 4096
  s_nop 0
  buffer_load_dwordx4 v11, s[4:7], s30 offen lds
  v_mfma_f32_32x32x16_bf16 v[224:239], v[104:107], v[100:103], v[224:239]
  s_add_u32 m0, s24, 5120
  s_nop 0
  buffer_load_dwordx4 v12, s[4:7], s31 offen lds
  v_mfma_f32_32x32x16_bf16 v[240:255], v[108:111], v[100:103], v[240:255]
  s_waitcnt lgkmcnt(0)
  v_mfma_f32_32x32x16_bf16 v[128:143], v[80:83], v[64:67], v[128:143]
  ds_read_b64_tr_b16 v[104:105], v10 offset:22528
  ds_read_b64_tr_b16 v[106:107], v10 offset:23040
  v_mfma_f32_32x32x16_bf16 v[144:159], v[84:87], v[64:67], v[144:159]
  ds_read_b128 v[88:91], v5 offset:32768
  ds_read_b64_tr_b16 v[108:109], v10 offset:30720
  v_mfma_f32_32x32x16_bf16 v[160:175], v[80:83], v[68:71], v[160:175]
  ds_read_b64_tr_b16 v[110:111], v10 offset:31232
  ds_read_b128 v[92:95], v5 offset:36864
  v_mfma_f32_32x32x16_bf16 v[176:191], v[84:87], v[68:71], v[176:191]
  ds_read_b128 v[96:99], v5 offset:40960
  ds_read_b128 v[100:103], v5 offset:45056
  v_mfma_f32_32x32x16_bf16 v[192:207], v[80:83], v[72:75], v[192:207]
  s_add_u32 m0, s25, 3072
  s_nop 0
  buffer_load_dwordx4 v13, s[72:75], s37 offen lds
  v_mfma_f32_32x32x16_bf16 v[208:223], v[84:87], v[72:75], v[208:223]
  s_add_u32 m0, s24, 6144
  s_nop 0
  buffer_load_dwordx4 v11, s[4:7], s32 offen lds
  v_mfma_f32_32x32x16_bf16 v[224:239], v[80:83], v[76:79], v[224:239]
  s_add_u32 m0, s24, 7168
  s_nop 0
  buffer_load_dwordx4 v12, s[4:7], s33 offen lds
  v_mfma_f32_32x32x16_bf16 v[240:255], v[84:87], v[76:79], v[240:255]
  s_add_u32 s4, s4, 128
  s_addc_u32 s5, s5, 0
  s_add_u32 s72, s72, s38
  s_addc_u32 s73, s73, 0
  s_waitcnt lgkmcnt(0)
  s_waitcnt vmcnt(12)
  s_barrier
  v_mfma_f32_32x32x16_bf16 v[128:143], v[104:107], v[88:91], v[128:143]
  ds_read_b64_tr_b16 v[80:81], v10 offset:32768
  ds_read_b64_tr_b16 v[82:83], v10 offset:33280
  v_mfma_f32_32x32x16_bf16 v[144:159], v[108:111], v[88:91], v[144:159]
  ds_read_b128 v[64:67], v6 offset:0
  ds_read_b64_tr_b16 v[84:85], v10 offset:40960
  v_mfma_f32_32x32x16_bf16 v[160:175], v[104:107], v[92:95], v[160:175]
  ds_read_b64_tr_b16 v[86:87], v10 offset:41472
  ds_read_b128 v[68:71], v6 offset:4096
  v_mfma_f32_32x32x16_bf16 v[176:191], v[108:111], v[92:95], v[176:191]
  ds_read_b128 v[72:75], v6 offset:8192
  ds_read_b128 v[76:79], v6 offset:12288
  v_mfma_f32_32x32x16_bf16 v[192:207], v[104:107], v[96:99], v[192:207]
  v_mfma_f32_32x32x16_bf16 v[208:223], v[108:111], v[96:99], v[208:223]
  v_mfma_f32_32x32x16_bf16 v[224:239], v[104:107], v[100:103], v[224:239]
  v_mfma_f32_32x32x16_bf16 v[240:255], v[108:111], v[100:103], v[240:255]
  s_waitcnt lgkmcnt(0)
  v_mfma_f32_32x32x16_bf16 v[128:143], v[80:83], v[64:67], v[128:143]
  ds_read_b64_tr_b16 v[104:105], v10 offset:34816
  ds_read_b64_tr_b16 v[106:107], v10 offset:35328
  v_mfma_f32_32x32x16_bf16 v[144:159], v[84:87], v[64:67], v[144:159]
  ds_read_b128 v[88:91], v7 offset:0
  ds_read_b64_tr_b16 v[108:109], v10 offset:43008
  v_mfma_f32_32x32x16_bf16 v[160:175], v[80:83], v[68:71], v[160:175]
  ds_read_b64_tr_b16 v[110:111], v10 offset:43520
  ds_read_b128 v[92:95], v7 offset:4096
  v_mfma_f32_32x32x16_bf16 v[176:191], v[84:87], v[68:71], v[176:191]
  ds_read_b128 v[96:99], v7 offset:8192
  ds_read_b128 v[100:103], v7 offset:12288
  v_mfma_f32_32x32x16_bf16 v[192:207], v[80:83], v[72:75], v[192:207]
  v_mfma_f32_32x32x16_bf16 v[208:223], v[84:87], v[72:75], v[208:223]
  v_mfma_f32_32x32x16_bf16 v[224:239], v[80:83], v[76:79], v[224:239]
  v_mfma_f32_32x32x16_bf16 v[240:255], v[84:87], v[76:79], v[240:255]
  s_waitcnt lgkmcnt(0)
  v_mfma_f32_32x32x16_bf16 v[128:143], v[104:107], v[88:91], v[128:143]
  ds_read_b64_tr_b16 v[80:81], v10 offset:36864
  ds_read_b64_tr_b16 v[82:83], v10 offset:37376
  v_mfma_f32_32x32x16_bf16 v[144:159], v[108:111], v[88:91], v[144:159]
  ds_read_b128 v[64:67], v8 offset:0
  ds_read_b64_tr_b16 v[84:85], v10 offset:45056
  v_mfma_f32_32x32x16_bf16 v[160:175], v[104:107], v[92:95], v[160:175]
  ds_read_b64_tr_b16 v[86:87], v10 offset:45568
  ds_read_b128 v[68:71], v8 offset:4096
  v_mfma_f32_32x32x16_bf16 v[176:191], v[108:111], v[92:95], v[176:191]
  ds_read_b128 v[72:75], v8 offset:8192
  ds_read_b128 v[76:79], v8 offset:12288
  v_mfma_f32_32x32x16_bf16 v[192:207], v[104:107], v[96:99], v[192:207]
  v_mfma_f32_32x32x16_bf16 v[208:223], v[108:111], v[96:99], v[208:223]
  v_mfma_f32_32x32x16_bf16 v[224:239], v[104:107], v[100:103], v[224:239]
  v_mfma_f32_32x32x16_bf16 v[240:255], v[108:111], v[100:103], v[240:255]
  s_waitcnt lgkmcnt(0)
  v_mfma_f32_32x32x16_bf16 v[128:143], v[80:83], v[64:67], v[128:143]
  ds_read_b64_tr_b16 v[104:105], v10 offset:38912
  ds_read_b64_tr_b16 v[106:107], v10 offset:39424
  v_mfma_f32_32x32x16_bf16 v[144:159], v[84:87], v[64:67], v[144:159]
  ds_read_b128 v[88:91], v9 offset:0
  ds_read_b64_tr_b16 v[108:109], v10 offset:47104
  v_mfma_f32_32x32x16_bf16 v[160:175], v[80:83], v[68:71], v[160:175]
  ds_read_b64_tr_b16 v[110:111], v10 offset:47616
  ds_read_b128 v[92:95], v9 offset:4096
  v_mfma_f32_32x32x16_bf16 v[176:191], v[84:87], v[68:71], v[176:191]
  ds_read_b128 v[96:99], v9 offset:8192
  ds_read_b128 v[100:103], v9 offset:12288
  v_mfma_f32_32x32x16_bf16 v[192:207], v[80:83], v[72:75], v[192:207]
  v_mfma_f32_32x32x16_bf16 v[208:223], v[84:87], v[72:75], v[208:223]
  v_mfma_f32_32x32x16_bf16 v[224:239], v[80:83], v[76:79], v[224:239]
  v_mfma_f32_32x32x16_bf16 v[240:255], v[84:87], v[76:79], v[240:255]
  s_waitcnt lgkmcnt(0)
  s_waitcnt vmcnt(0)
  s_barrier
  v_mfma_f32_32x32x16_bf16 v[128:143], v[104:107], v[88:91], v[128:143]
  ds_read_b64_tr_b16 v[80:81], v10 offset:0
  ds_read_b64_tr_b16 v[82:83], v10 offset:512
  v_mfma_f32_32x32x16_bf16 v[144:159], v[108:111], v[88:91], v[144:159]
  ds_read_b128 v[64:67], v2 offset:0
  ds_read_b64_tr_b16 v[84:85], v10 offset:8192
  v_mfma_f32_32x32x16_bf16 v[160:175], v[104:107], v[92:95], v[160:175]
  ds_read_b64_tr_b16 v[86:87], v10 offset:8704
  ds_read_b128 v[68:71], v2 offset:4096
  v_mfma_f32_32x32x16_bf16 v[176:191], v[108:111], v[92:95], v[176:191]
  ds_read_b128 v[72:75], v2 offset:8192
  ds_read_b128 v[76:79], v2 offset:12288
  v_mfma_f32_32x32x16_bf16 v[192:207], v[104:107], v[96:99], v[192:207]
  v_mfma_f32_32x32x16_bf16 v[208:223], v[108:111], v[96:99], v[208:223]
  v_mfma_f32_32x32x16_bf16 v[224:239], v[104:107], v[100:103], v[224:239]
  v_mfma_f32_32x32x16_bf16 v[240:255], v[108:111], v[100:103], v[240:255]
  s_waitcnt lgkmcnt(0)
  v_mfma_f32_32x32x16_bf16 v[128:143], v[80:83], v[64:67], v[128:143]
  ds_read_b64_tr_b16 v[104:105], v10 offset:2048
  ds_read_b64_tr_b16 v[106:107], v10 offset:2560
  v_mfma_f32_32x32x16_bf16 v[144:159], v[84:87], v[64:67], v[144:159]
  ds_read_b128 v[88:91], v3 offset:0
  ds_read_b64_tr_b16 v[108:109], v10 offset:10240
  v_mfma_f32_32x32x16_bf16 v[160:175], v[80:83], v[68:71], v[160:175]
  ds_read_b64_tr_b16 v[110:111], v10 offset:10752
  ds_read_b128 v[92:95], v3 offset:4096
  v_mfma_f32_32x32x16_bf16 v[176:191], v[84:87], v[68:71], v[176:191]
  ds_read_b128 v[96:99], v3 offset:8192
  ds_read_b128 v[100:103], v3 offset:12288
  v_mfma_f32_32x32x16_bf16 v[192:207], v[80:83], v[72:75], v[192:207]
  v_mfma_f32_32x32x16_bf16 v[208:223], v[84:87], v[72:75], v[208:223]
  v_mfma_f32_32x32x16_bf16 v[224:239], v[80:83], v[76:79], v[224:239]
  v_mfma_f32_32x32x16_bf16 v[240:255], v[84:87], v[76:79], v[240:255]
  s_waitcnt lgkmcnt(0)
  v_mfma_f32_32x32x16_bf16 v[128:143], v[104:107], v[88:91], v[128:143]
  ds_read_b64_tr_b16 v[80:81], v10 offset:4096
  ds_read_b64_tr_b16 v[82:83], v10 offset:4608
  v_mfma_f32_32x32x16_bf16 v[144:159], v[108:111], v[88:91], v[144:159]
  ds_read_b128 v[64:67], v4 offset:0
  ds_read_b64_tr_b16 v[84:85], v10 offset:12288
  v_mfma_f32_32x32x16_bf16 v[160:175], v[104:107], v[92:95], v[160:175]
  ds_read_b64_tr_b16 v[86:87], v10 offset:12800
  ds_read_b128 v[68:71], v4 offset:4096
  v_mfma_f32_32x32x16_bf16 v[176:191], v[108:111], v[92:95], v[176:191]
  ds_read_b128 v[72:75], v4 offset:8192
  ds_read_b128 v[76:79], v4 offset:12288
  v_mfma_f32_32x32x16_bf16 v[192:207], v[104:107], v[96:99], v[192:207]
  v_mfma_f32_32x32x16_bf16 v[208:223], v[108:111], v[96:99], v[208:223]
  v_mfma_f32_32x32x16_bf16 v[224:239], v[104:107], v[100:103], v[224:239]
  v_mfma_f32_32x32x16_bf16 v[240:255], v[108:111], v[100:103], v[240:255]
  s_waitcnt lgkmcnt(0)
  v_mfma_f32_32x32x16_bf16 v[128:143], v[80:83], v[64:67], v[128:143]
  ds_read_b64_tr_b16 v[104:105], v10 offset:6144
  ds_read_b64_tr_b16 v[106:107], v10 offset:6656
  v_mfma_f32_32x32x16_bf16 v[144:159], v[84:87], v[64:67], v[144:159]
  ds_read_b128 v[88:91], v5 offset:0
  ds_read_b64_tr_b16 v[108:109], v10 offset:14336
  v_mfma_f32_32x32x16_bf16 v[160:175], v[80:83], v[68:71], v[160:175]
  ds_read_b64_tr_b16 v[110:111], v10 offset:14848
  ds_read_b128 v[92:95], v5 offset:4096
  v_mfma_f32_32x32x16_bf16 v[176:191], v[84:87], v[68:71], v[176:191]
  ds_read_b128 v[96:99], v5 offset:8192
  ds_read_b128 v[100:103], v5 offset:12288
  v_mfma_f32_32x32x16_bf16 v[192:207], v[80:83], v[72:75], v[192:207]
  v_mfma_f32_32x32x16_bf16 v[208:223], v[84:87], v[72:75], v[208:223]
  v_mfma_f32_32x32x16_bf16 v[224:239], v[80:83], v[76:79], v[224:239]
  v_mfma_f32_32x32x16_bf16 v[240:255], v[84:87], v[76:79], v[240:255]
  s_waitcnt lgkmcnt(0)
  v_mfma_f32_32x32x16_bf16 v[128:143], v[104:107], v[88:91], v[128:143]
  v_mfma_f32_32x32x16_bf16 v[144:159], v[108:111], v[88:91], v[144:159]
  v_mfma_f32_32x32x16_bf16 v[160:175], v[104:107], v[92:95], v[160:175]
  v_mfma_f32_32x32x16_bf16 v[176:191], v[108:111], v[92:95], v[176:191]
  v_mfma_f32_32x32x16_bf16 v[192:207], v[104:107], v[96:99], v[192:207]
  v_mfma_f32_32x32x16_bf16 v[208:223], v[108:111], v[96:99], v[208:223]
  v_mfma_f32_32x32x16_bf16 v[224:239], v[104:107], v[100:103], v[224:239]
  v_mfma_f32_32x32x16_bf16 v[240:255], v[108:111], v[100:103], v[240:255]
  s_nop 15
  s_cmp_lg_u32 s69, 0
  s_cbranch_scc1 k1_kernel_q_epi
  v_pk_mul_f32 v[20:21], v[128:129], s[80:81]
  v_pk_mul_f32 v[22:23], v[130:131], s[80:81]
  v_pk_mul_f32 v[24:25], v[132:133], s[80:81]
  v_pk_mul_f32 v[26:27], v[134:135], s[80:81]
  v_pk_mul_f32 v[28:29], v[136:137], s[80:81]
  v_pk_mul_f32 v[30:31], v[138:139], s[80:81]
  v_pk_mul_f32 v[32:33], v[140:141], s[80:81]
  v_pk_mul_f32 v[34:35], v[142:143], s[80:81]
  v_exp_f32 v20, v20
  v_exp_f32 v21, v21
  v_exp_f32 v22, v22
  v_exp_f32 v23, v23
  v_exp_f32 v24, v24
  v_exp_f32 v25, v25
  v_exp_f32 v26, v26
  v_exp_f32 v27, v27
  v_exp_f32 v28, v28
  v_exp_f32 v29, v29
  v_exp_f32 v30, v30
  v_exp_f32 v31, v31
  v_exp_f32 v32, v32
  v_exp_f32 v33, v33
  v_exp_f32 v34, v34
  v_exp_f32 v35, v35
  v_pk_add_f32 v[20:21], v[20:21], s[82:83]
  v_pk_add_f32 v[22:23], v[22:23], s[82:83]
  v_pk_add_f32 v[24:25], v[24:25], s[82:83]
  v_pk_add_f32 v[26:27], v[26:27], s[82:83]
  v_pk_add_f32 v[28:29], v[28:29], s[82:83]
  v_pk_add_f32 v[30:31], v[30:31], s[82:83]
  v_pk_add_f32 v[32:33], v[32:33], s[82:83]
  v_pk_add_f32 v[34:35], v[34:35], s[82:83]
  v_rcp_f32 v20, v20
  v_rcp_f32 v21, v21
  v_rcp_f32 v22, v22
  v_rcp_f32 v23, v23
  v_rcp_f32 v24, v24
  v_rcp_f32 v25, v25
  v_rcp_f32 v26, v26
  v_rcp_f32 v27, v27
  v_rcp_f32 v28, v28
  v_rcp_f32 v29, v29
  v_rcp_f32 v30, v30
  v_rcp_f32 v31, v31
  v_rcp_f32 v32, v32
  v_rcp_f32 v33, v33
  v_rcp_f32 v34, v34
  v_rcp_f32 v35, v35
  v_pk_mul_f32 v[128:129], v[128:129], v[144:145]
  v_pk_mul_f32 v[130:131], v[130:131], v[146:147]
  v_pk_mul_f32 v[132:133], v[132:133], v[148:149]
  v_pk_mul_f32 v[134:135], v[134:135], v[150:151]
  v_pk_mul_f32 v[136:137], v[136:137], v[152:153]
  v_pk_mul_f32 v[138:139], v[138:139], v[154:155]
  v_pk_mul_f32 v[140:141], v[140:141], v[156:157]
  v_pk_mul_f32 v[142:143], v[142:143], v[158:159]
  v_pk_mul_f32 v[20:21], v[20:21], v[128:129]
  v_pk_mul_f32 v[22:23], v[22:23], v[130:131]
  v_pk_mul_f32 v[24:25], v[24:25], v[132:133]
  v_pk_mul_f32 v[26:27], v[26:27], v[134:135]
  v_pk_mul_f32 v[28:29], v[28:29], v[136:137]
  v_pk_mul_f32 v[30:31], v[30:31], v[138:139]
  v_pk_mul_f32 v[32:33], v[32:33], v[140:141]
  v_pk_mul_f32 v[34:35], v[34:35], v[142:143]
  v_cvt_pk_bf16_f32 v40, v20, v21
  v_cvt_pk_bf16_f32 v41, v22, v23
  v_cvt_pk_bf16_f32 v42, v24, v25
  v_cvt_pk_bf16_f32 v43, v26, v27
  v_cvt_pk_bf16_f32 v44, v28, v29
  v_cvt_pk_bf16_f32 v45, v30, v31
  v_cvt_pk_bf16_f32 v46, v32, v33
  v_cvt_pk_bf16_f32 v47, v34, v35
  buffer_store_dwordx4 v[40:43], v16, s[16:19], s78 offen sc1
  buffer_store_dwordx4 v[44:47], v16, s[16:19], s78 offen offset:256 sc1
  s_add_u32 s78, s78, 98304
  v_pk_mul_f32 v[20:21], v[160:161], s[80:81]
  v_pk_mul_f32 v[22:23], v[162:163], s[80:81]
  v_pk_mul_f32 v[24:25], v[164:165], s[80:81]
  v_pk_mul_f32 v[26:27], v[166:167], s[80:81]
  v_pk_mul_f32 v[28:29], v[168:169], s[80:81]
  v_pk_mul_f32 v[30:31], v[170:171], s[80:81]
  v_pk_mul_f32 v[32:33], v[172:173], s[80:81]
  v_pk_mul_f32 v[34:35], v[174:175], s[80:81]
  v_exp_f32 v20, v20
  v_exp_f32 v21, v21
  v_exp_f32 v22, v22
  v_exp_f32 v23, v23
  v_exp_f32 v24, v24
  v_exp_f32 v25, v25
  v_exp_f32 v26, v26
  v_exp_f32 v27, v27
  v_exp_f32 v28, v28
  v_exp_f32 v29, v29
  v_exp_f32 v30, v30
  v_exp_f32 v31, v31
  v_exp_f32 v32, v32
  v_exp_f32 v33, v33
  v_exp_f32 v34, v34
  v_exp_f32 v35, v35
  v_pk_add_f32 v[20:21], v[20:21], s[82:83]
  v_pk_add_f32 v[22:23], v[22:23], s[82:83]
  v_pk_add_f32 v[24:25], v[24:25], s[82:83]
  v_pk_add_f32 v[26:27], v[26:27], s[82:83]
  v_pk_add_f32 v[28:29], v[28:29], s[82:83]
  v_pk_add_f32 v[30:31], v[30:31], s[82:83]
  v_pk_add_f32 v[32:33], v[32:33], s[82:83]
  v_pk_add_f32 v[34:35], v[34:35], s[82:83]
  v_rcp_f32 v20, v20
  v_rcp_f32 v21, v21
  v_rcp_f32 v22, v22
  v_rcp_f32 v23, v23
  v_rcp_f32 v24, v24
  v_rcp_f32 v25, v25
  v_rcp_f32 v26, v26
  v_rcp_f32 v27, v27
  v_rcp_f32 v28, v28
  v_rcp_f32 v29, v29
  v_rcp_f32 v30, v30
  v_rcp_f32 v31, v31
  v_rcp_f32 v32, v32
  v_rcp_f32 v33, v33
  v_rcp_f32 v34, v34
  v_rcp_f32 v35, v35
  v_pk_mul_f32 v[160:161], v[160:161], v[176:177]
  v_pk_mul_f32 v[162:163], v[162:163], v[178:179]
  v_pk_mul_f32 v[164:165], v[164:165], v[180:181]
  v_pk_mul_f32 v[166:167], v[166:167], v[182:183]
  v_pk_mul_f32 v[168:169], v[168:169], v[184:185]
  v_pk_mul_f32 v[170:171], v[170:171], v[186:187]
  v_pk_mul_f32 v[172:173], v[172:173], v[188:189]
  v_pk_mul_f32 v[174:175], v[174:175], v[190:191]
  v_pk_mul_f32 v[20:21], v[20:21], v[160:161]
  v_pk_mul_f32 v[22:23], v[22:23], v[162:163]
  v_pk_mul_f32 v[24:25], v[24:25], v[164:165]
  v_pk_mul_f32 v[26:27], v[26:27], v[166:167]
  v_pk_mul_f32 v[28:29], v[28:29], v[168:169]
  v_pk_mul_f32 v[30:31], v[30:31], v[170:171]
  v_pk_mul_f32 v[32:33], v[32:33], v[172:173]
  v_pk_mul_f32 v[34:35], v[34:35], v[174:175]
  v_cvt_pk_bf16_f32 v48, v20, v21
  v_cvt_pk_bf16_f32 v49, v22, v23
  v_cvt_pk_bf16_f32 v50, v24, v25
  v_cvt_pk_bf16_f32 v51, v26, v27
  v_cvt_pk_bf16_f32 v52, v28, v29
  v_cvt_pk_bf16_f32 v53, v30, v31
  v_cvt_pk_bf16_f32 v54, v32, v33
  v_cvt_pk_bf16_f32 v55, v34, v35
  buffer_store_dwordx4 v[48:51], v16, s[16:19], s78 offen sc1
  buffer_store_dwordx4 v[52:55], v16, s[16:19], s78 offen offset:256 sc1
  s_add_u32 s78, s78, 98304
  v_pk_mul_f32 v[20:21], v[192:193], s[80:81]
  v_pk_mul_f32 v[22:23], v[194:195], s[80:81]
  v_pk_mul_f32 v[24:25], v[196:197], s[80:81]
  v_pk_mul_f32 v[26:27], v[198:199], s[80:81]
  v_pk_mul_f32 v[28:29], v[200:201], s[80:81]
  v_pk_mul_f32 v[30:31], v[202:203], s[80:81]
  v_pk_mul_f32 v[32:33], v[204:205], s[80:81]
  v_pk_mul_f32 v[34:35], v[206:207], s[80:81]
  v_exp_f32 v20, v20
  v_exp_f32 v21, v21
  v_exp_f32 v22, v22
  v_exp_f32 v23, v23
  v_exp_f32 v24, v24
  v_exp_f32 v25, v25
  v_exp_f32 v26, v26
  v_exp_f32 v27, v27
  v_exp_f32 v28, v28
  v_exp_f32 v29, v29
  v_exp_f32 v30, v30
  v_exp_f32 v31, v31
  v_exp_f32 v32, v32
  v_exp_f32 v33, v33
  v_exp_f32 v34, v34
  v_exp_f32 v35, v35
  v_pk_add_f32 v[20:21], v[20:21], s[82:83]
  v_pk_add_f32 v[22:23], v[22:23], s[82:83]
  v_pk_add_f32 v[24:25], v[24:25], s[82:83]
  v_pk_add_f32 v[26:27], v[26:27], s[82:83]
  v_pk_add_f32 v[28:29], v[28:29], s[82:83]
  v_pk_add_f32 v[30:31], v[30:31], s[82:83]
  v_pk_add_f32 v[32:33], v[32:33], s[82:83]
  v_pk_add_f32 v[34:35], v[34:35], s[82:83]
  v_rcp_f32 v20, v20
  v_rcp_f32 v21, v21
  v_rcp_f32 v22, v22
  v_rcp_f32 v23, v23
  v_rcp_f32 v24, v24
  v_rcp_f32 v25, v25
  v_rcp_f32 v26, v26
  v_rcp_f32 v27, v27
  v_rcp_f32 v28, v28
  v_rcp_f32 v29, v29
  v_rcp_f32 v30, v30
  v_rcp_f32 v31, v31
  v_rcp_f32 v32, v32
  v_rcp_f32 v33, v33
  v_rcp_f32 v34, v34
  v_rcp_f32 v35, v35
  v_pk_mul_f32 v[192:193], v[192:193], v[208:209]
  v_pk_mul_f32 v[194:195], v[194:195], v[210:211]
  v_pk_mul_f32 v[196:197], v[196:197], v[212:213]
  v_pk_mul_f32 v[198:199], v[198:199], v[214:215]
  v_pk_mul_f32 v[200:201], v[200:201], v[216:217]
  v_pk_mul_f32 v[202:203], v[202:203], v[218:219]
  v_pk_mul_f32 v[204:205], v[204:205], v[220:221]
  v_pk_mul_f32 v[206:207], v[206:207], v[222:223]
  v_pk_mul_f32 v[20:21], v[20:21], v[192:193]
  v_pk_mul_f32 v[22:23], v[22:23], v[194:195]
  v_pk_mul_f32 v[24:25], v[24:25], v[196:197]
  v_pk_mul_f32 v[26:27], v[26:27], v[198:199]
  v_pk_mul_f32 v[28:29], v[28:29], v[200:201]
  v_pk_mul_f32 v[30:31], v[30:31], v[202:203]
  v_pk_mul_f32 v[32:33], v[32:33], v[204:205]
  v_pk_mul_f32 v[34:35], v[34:35], v[206:207]
  v_cvt_pk_bf16_f32 v40, v20, v21
  v_cvt_pk_bf16_f32 v41, v22, v23
  v_cvt_pk_bf16_f32 v42, v24, v25
  v_cvt_pk_bf16_f32 v43, v26, v27
  v_cvt_pk_bf16_f32 v44, v28, v29
  v_cvt_pk_bf16_f32 v45, v30, v31
  v_cvt_pk_bf16_f32 v46, v32, v33
  v_cvt_pk_bf16_f32 v47, v34, v35
  buffer_store_dwordx4 v[40:43], v16, s[16:19], s78 offen sc1
  buffer_store_dwordx4 v[44:47], v16, s[16:19], s78 offen offset:256 sc1
  s_add_u32 s78, s78, 98304
  v_pk_mul_f32 v[20:21], v[224:225], s[80:81]
  v_pk_mul_f32 v[22:23], v[226:227], s[80:81]
  v_pk_mul_f32 v[24:25], v[228:229], s[80:81]
  v_pk_mul_f32 v[26:27], v[230:231], s[80:81]
  v_pk_mul_f32 v[28:29], v[232:233], s[80:81]
  v_pk_mul_f32 v[30:31], v[234:235], s[80:81]
  v_pk_mul_f32 v[32:33], v[236:237], s[80:81]
  v_pk_mul_f32 v[34:35], v[238:239], s[80:81]
  v_exp_f32 v20, v20
  v_exp_f32 v21, v21
  v_exp_f32 v22, v22
  v_exp_f32 v23, v23
  v_exp_f32 v24, v24
  v_exp_f32 v25, v25
  v_exp_f32 v26, v26
  v_exp_f32 v27, v27
  v_exp_f32 v28, v28
  v_exp_f32 v29, v29
  v_exp_f32 v30, v30
  v_exp_f32 v31, v31
  v_exp_f32 v32, v32
  v_exp_f32 v33, v33
  v_exp_f32 v34, v34
  v_exp_f32 v35, v35
  v_pk_add_f32 v[20:21], v[20:21], s[82:83]
  v_pk_add_f32 v[22:23], v[22:23], s[82:83]
  v_pk_add_f32 v[24:25], v[24:25], s[82:83]
  v_pk_add_f32 v[26:27], v[26:27], s[82:83]
  v_pk_add_f32 v[28:29], v[28:29], s[82:83]
  v_pk_add_f32 v[30:31], v[30:31], s[82:83]
  v_pk_add_f32 v[32:33], v[32:33], s[82:83]
  v_pk_add_f32 v[34:35], v[34:35], s[82:83]
  v_rcp_f32 v20, v20
  v_rcp_f32 v21, v21
  v_rcp_f32 v22, v22
  v_rcp_f32 v23, v23
  v_rcp_f32 v24, v24
  v_rcp_f32 v25, v25
  v_rcp_f32 v26, v26
  v_rcp_f32 v27, v27
  v_rcp_f32 v28, v28
  v_rcp_f32 v29, v29
  v_rcp_f32 v30, v30
  v_rcp_f32 v31, v31
  v_rcp_f32 v32, v32
  v_rcp_f32 v33, v33
  v_rcp_f32 v34, v34
  v_rcp_f32 v35, v35
  v_pk_mul_f32 v[224:225], v[224:225], v[240:241]
  v_pk_mul_f32 v[226:227], v[226:227], v[242:243]
  v_pk_mul_f32 v[228:229], v[228:229], v[244:245]
  v_pk_mul_f32 v[230:231], v[230:231], v[246:247]
  v_pk_mul_f32 v[232:233], v[232:233], v[248:249]
  v_pk_mul_f32 v[234:235], v[234:235], v[250:251]
  v_pk_mul_f32 v[236:237], v[236:237], v[252:253]
  v_pk_mul_f32 v[238:239], v[238:239], v[254:255]
  v_pk_mul_f32 v[20:21], v[20:21], v[224:225]
  v_pk_mul_f32 v[22:23], v[22:23], v[226:227]
  v_pk_mul_f32 v[24:25], v[24:25], v[228:229]
  v_pk_mul_f32 v[26:27], v[26:27], v[230:231]
  v_pk_mul_f32 v[28:29], v[28:29], v[232:233]
  v_pk_mul_f32 v[30:31], v[30:31], v[234:235]
  v_pk_mul_f32 v[32:33], v[32:33], v[236:237]
  v_pk_mul_f32 v[34:35], v[34:35], v[238:239]
  v_cvt_pk_bf16_f32 v48, v20, v21
  v_cvt_pk_bf16_f32 v49, v22, v23
  v_cvt_pk_bf16_f32 v50, v24, v25
  v_cvt_pk_bf16_f32 v51, v26, v27
  v_cvt_pk_bf16_f32 v52, v28, v29
  v_cvt_pk_bf16_f32 v53, v30, v31
  v_cvt_pk_bf16_f32 v54, v32, v33
  v_cvt_pk_bf16_f32 v55, v34, v35
  buffer_store_dwordx4 v[48:51], v16, s[16:19], s78 offen sc1
  buffer_store_dwordx4 v[52:55], v16, s[16:19], s78 offen offset:256 sc1
  s_branch k1_kernel_fin
k1_kernel_q_epi:
  s_mov_b32 s80, 1051011932
  s_mov_b32 s81, s80
  v_pk_mul_f32 v[128:129], v[128:129], s[80:81]
  v_pk_mul_f32 v[130:131], v[130:131], s[80:81]
  v_pk_mul_f32 v[132:133], v[132:133], s[80:81]
  v_pk_mul_f32 v[134:135], v[134:135], s[80:81]
  v_pk_mul_f32 v[136:137], v[136:137], s[80:81]
  v_pk_mul_f32 v[138:139], v[138:139], s[80:81]
  v_pk_mul_f32 v[140:141], v[140:141], s[80:81]
  v_pk_mul_f32 v[142:143], v[142:143], s[80:81]
  v_cvt_pk_bf16_f32 v32, v128, v129
  v_cvt_pk_bf16_f32 v33, v130, v131
  v_cvt_pk_bf16_f32 v34, v132, v133
  v_cvt_pk_bf16_f32 v35, v134, v135
  v_cvt_pk_bf16_f32 v36, v136, v137
  v_cvt_pk_bf16_f32 v37, v138, v139
  v_cvt_pk_bf16_f32 v38, v140, v141
  v_cvt_pk_bf16_f32 v39, v142, v143
  buffer_store_dwordx2 v[32:33], v20, s[16:19], s86 offen sc1
  buffer_store_dwordx2 v[34:35], v21, s[16:19], s86 offen sc1
  buffer_store_dwordx2 v[36:37], v22, s[16:19], s86 offen sc1
  buffer_store_dwordx2 v[38:39], v23, s[16:19], s86 offen sc1
  v_pk_mul_f32 v[144:145], v[144:145], s[80:81]
  v_pk_mul_f32 v[146:147], v[146:147], s[80:81]
  v_pk_mul_f32 v[148:149], v[148:149], s[80:81]
  v_pk_mul_f32 v[150:151], v[150:151], s[80:81]
  v_pk_mul_f32 v[152:153], v[152:153], s[80:81]
  v_pk_mul_f32 v[154:155], v[154:155], s[80:81]
  v_pk_mul_f32 v[156:157], v[156:157], s[80:81]
  v_pk_mul_f32 v[158:159], v[158:159], s[80:81]
  v_cvt_pk_bf16_f32 v40, v144, v145
  v_cvt_pk_bf16_f32 v41, v146, v147
  v_cvt_pk_bf16_f32 v42, v148, v149
  v_cvt_pk_bf16_f32 v43, v150, v151
  v_cvt_pk_bf16_f32 v44, v152, v153
  v_cvt_pk_bf16_f32 v45, v154, v155
  v_cvt_pk_bf16_f32 v46, v156, v157
  v_cvt_pk_bf16_f32 v47, v158, v159
  buffer_store_dwordx2 v[40:41], v24, s[16:19], s86 offen sc1
  buffer_store_dwordx2 v[42:43], v25, s[16:19], s86 offen sc1
  buffer_store_dwordx2 v[44:45], v26, s[16:19], s86 offen sc1
  buffer_store_dwordx2 v[46:47], v27, s[16:19], s86 offen sc1
  s_add_u32 s86, s86, 1280
  v_pk_mul_f32 v[160:161], v[160:161], s[80:81]
  v_pk_mul_f32 v[162:163], v[162:163], s[80:81]
  v_pk_mul_f32 v[164:165], v[164:165], s[80:81]
  v_pk_mul_f32 v[166:167], v[166:167], s[80:81]
  v_pk_mul_f32 v[168:169], v[168:169], s[80:81]
  v_pk_mul_f32 v[170:171], v[170:171], s[80:81]
  v_pk_mul_f32 v[172:173], v[172:173], s[80:81]
  v_pk_mul_f32 v[174:175], v[174:175], s[80:81]
  v_cvt_pk_bf16_f32 v32, v160, v161
  v_cvt_pk_bf16_f32 v33, v162, v163
  v_cvt_pk_bf16_f32 v34, v164, v165
  v_cvt_pk_bf16_f32 v35, v166, v167
  v_cvt_pk_bf16_f32 v36, v168, v169
  v_cvt_pk_bf16_f32 v37, v170, v171
  v_cvt_pk_bf16_f32 v38, v172, v173
  v_cvt_pk_bf16_f32 v39, v174, v175
  buffer_store_dwordx2 v[32:33], v20, s[16:19], s86 offen sc1
  buffer_store_dwordx2 v[34:35], v21, s[16:19], s86 offen sc1
  buffer_store_dwordx2 v[36:37], v22, s[16:19], s86 offen sc1
  buffer_store_dwordx2 v[38:39], v23, s[16:19], s86 offen sc1
  v_pk_mul_f32 v[176:177], v[176:177], s[80:81]
  v_pk_mul_f32 v[178:179], v[178:179], s[80:81]
  v_pk_mul_f32 v[180:181], v[180:181], s[80:81]
  v_pk_mul_f32 v[182:183], v[182:183], s[80:81]
  v_pk_mul_f32 v[184:185], v[184:185], s[80:81]
  v_pk_mul_f32 v[186:187], v[186:187], s[80:81]
  v_pk_mul_f32 v[188:189], v[188:189], s[80:81]
  v_pk_mul_f32 v[190:191], v[190:191], s[80:81]
  v_cvt_pk_bf16_f32 v40, v176, v177
  v_cvt_pk_bf16_f32 v41, v178, v179
  v_cvt_pk_bf16_f32 v42, v180, v181
  v_cvt_pk_bf16_f32 v43, v182, v183
  v_cvt_pk_bf16_f32 v44, v184, v185
  v_cvt_pk_bf16_f32 v45, v186, v187
  v_cvt_pk_bf16_f32 v46, v188, v189
  v_cvt_pk_bf16_f32 v47, v190, v191
  buffer_store_dwordx2 v[40:41], v24, s[16:19], s86 offen sc1
  buffer_store_dwordx2 v[42:43], v25, s[16:19], s86 offen sc1
  buffer_store_dwordx2 v[44:45], v26, s[16:19], s86 offen sc1
  buffer_store_dwordx2 v[46:47], v27, s[16:19], s86 offen sc1
  s_add_u32 s86, s86, 1280
  v_pk_mul_f32 v[192:193], v[192:193], s[80:81]
  v_pk_mul_f32 v[194:195], v[194:195], s[80:81]
  v_pk_mul_f32 v[196:197], v[196:197], s[80:81]
  v_pk_mul_f32 v[198:199], v[198:199], s[80:81]
  v_pk_mul_f32 v[200:201], v[200:201], s[80:81]
  v_pk_mul_f32 v[202:203], v[202:203], s[80:81]
  v_pk_mul_f32 v[204:205], v[204:205], s[80:81]
  v_pk_mul_f32 v[206:207], v[206:207], s[80:81]
  v_cvt_pk_bf16_f32 v32, v192, v193
  v_cvt_pk_bf16_f32 v33, v194, v195
  v_cvt_pk_bf16_f32 v34, v196, v197
  v_cvt_pk_bf16_f32 v35, v198, v199
  v_cvt_pk_bf16_f32 v36, v200, v201
  v_cvt_pk_bf16_f32 v37, v202, v203
  v_cvt_pk_bf16_f32 v38, v204, v205
  v_cvt_pk_bf16_f32 v39, v206, v207
  buffer_store_dwordx2 v[32:33], v20, s[16:19], s86 offen sc1
  buffer_store_dwordx2 v[34:35], v21, s[16:19], s86 offen sc1
  buffer_store_dwordx2 v[36:37], v22, s[16:19], s86 offen sc1
  buffer_store_dwordx2 v[38:39], v23, s[16:19], s86 offen sc1
  v_pk_mul_f32 v[208:209], v[208:209], s[80:81]
  v_pk_mul_f32 v[210:211], v[210:211], s[80:81]
  v_pk_mul_f32 v[212:213], v[212:213], s[80:81]
  v_pk_mul_f32 v[214:215], v[214:215], s[80:81]
  v_pk_mul_f32 v[216:217], v[216:217], s[80:81]
  v_pk_mul_f32 v[218:219], v[218:219], s[80:81]
  v_pk_mul_f32 v[220:221], v[220:221], s[80:81]
  v_pk_mul_f32 v[222:223], v[222:223], s[80:81]
  v_cvt_pk_bf16_f32 v40, v208, v209
  v_cvt_pk_bf16_f32 v41, v210, v211
  v_cvt_pk_bf16_f32 v42, v212, v213
  v_cvt_pk_bf16_f32 v43, v214, v215
  v_cvt_pk_bf16_f32 v44, v216, v217
  v_cvt_pk_bf16_f32 v45, v218, v219
  v_cvt_pk_bf16_f32 v46, v220, v221
  v_cvt_pk_bf16_f32 v47, v222, v223
  buffer_store_dwordx2 v[40:41], v24, s[16:19], s86 offen sc1
  buffer_store_dwordx2 v[42:43], v25, s[16:19], s86 offen sc1
  buffer_store_dwordx2 v[44:45], v26, s[16:19], s86 offen sc1
  buffer_store_dwordx2 v[46:47], v27, s[16:19], s86 offen sc1
  s_add_u32 s86, s86, 1280
  v_pk_mul_f32 v[224:225], v[224:225], s[80:81]
  v_pk_mul_f32 v[226:227], v[226:227], s[80:81]
  v_pk_mul_f32 v[228:229], v[228:229], s[80:81]
  v_pk_mul_f32 v[230:231], v[230:231], s[80:81]
  v_pk_mul_f32 v[232:233], v[232:233], s[80:81]
  v_pk_mul_f32 v[234:235], v[234:235], s[80:81]
  v_pk_mul_f32 v[236:237], v[236:237], s[80:81]
  v_pk_mul_f32 v[238:239], v[238:239], s[80:81]
  v_cvt_pk_bf16_f32 v32, v224, v225
  v_cvt_pk_bf16_f32 v33, v226, v227
  v_cvt_pk_bf16_f32 v34, v228, v229
  v_cvt_pk_bf16_f32 v35, v230, v231
  v_cvt_pk_bf16_f32 v36, v232, v233
  v_cvt_pk_bf16_f32 v37, v234, v235
  v_cvt_pk_bf16_f32 v38, v236, v237
  v_cvt_pk_bf16_f32 v39, v238, v239
  buffer_store_dwordx2 v[32:33], v20, s[16:19], s86 offen sc1
  buffer_store_dwordx2 v[34:35], v21, s[16:19], s86 offen sc1
  buffer_store_dwordx2 v[36:37], v22, s[16:19], s86 offen sc1
  buffer_store_dwordx2 v[38:39], v23, s[16:19], s86 offen sc1
  v_pk_mul_f32 v[240:241], v[240:241], s[80:81]
  v_pk_mul_f32 v[242:243], v[242:243], s[80:81]
  v_pk_mul_f32 v[244:245], v[244:245], s[80:81]
  v_pk_mul_f32 v[246:247], v[246:247], s[80:81]
  v_pk_mul_f32 v[248:249], v[248:249], s[80:81]
  v_pk_mul_f32 v[250:251], v[250:251], s[80:81]
  v_pk_mul_f32 v[252:253], v[252:253], s[80:81]
  v_pk_mul_f32 v[254:255], v[254:255], s[80:81]
  v_cvt_pk_bf16_f32 v40, v240, v241
  v_cvt_pk_bf16_f32 v41, v242, v243
  v_cvt_pk_bf16_f32 v42, v244, v245
  v_cvt_pk_bf16_f32 v43, v246, v247
  v_cvt_pk_bf16_f32 v44, v248, v249
  v_cvt_pk_bf16_f32 v45, v250, v251
  v_cvt_pk_bf16_f32 v46, v252, v253
  v_cvt_pk_bf16_f32 v47, v254, v255
  buffer_store_dwordx2 v[40:41], v24, s[16:19], s86 offen sc1
  buffer_store_dwordx2 v[42:43], v25, s[16:19], s86 offen sc1
  buffer_store_dwordx2 v[44:45], v26, s[16:19], s86 offen sc1
  buffer_store_dwordx2 v[46:47], v27, s[16:19], s86 offen sc1
  s_branch k1_kernel_fin
k1_kernel_spare:
  s_sub_u32 s22, s3, 2
  s_lshl_b32 s22, s22, 2
  s_add_u32 s22, s22, s65
  s_lshl_b32 s21, s22, 2
  s_add_u32 s21, s21, s20
  s_cmp_ge_u32 s22, 16
  s_cbranch_scc1 k1_kernel_xform
  s_mov_b32 s8, s44
  s_and_b32 s9, s45, 0xffff
  s_mov_b32 s10, 25600
  s_mov_b32 s11, 0x20000
  s_mov_b32 s12, s46
  s_and_b32 s13, s47, 0xffff
  s_mov_b32 s14, 25600
  s_mov_b32 s15, 0x20000
  s_mov_b32 s72, s58
  s_and_b32 s73, s59, 0xffff
  s_mov_b32 s74, 1280
  s_mov_b32 s75, 0x20000
  v_lshlrev_b32 v17, 3, v0
  s_movk_i32 s39, 0
  buffer_load_dwordx2 v[224:225], v17, s[8:11], s39 offen
  buffer_load_dwordx2 v[226:227], v17, s[12:15], s39 offen
  s_movk_i32 s39, 2048
  buffer_load_dwordx2 v[228:229], v17, s[8:11], s39 offen
  buffer_load_dwordx2 v[230:231], v17, s[12:15], s39 offen
  s_movk_i32 s39, 4096
  buffer_load_dwordx2 v[232:233], v17, s[8:11], s39 offen
  buffer_load_dwordx2 v[234:235], v17, s[12:15], s39 offen
  s_movk_i32 s39, 6144
  buffer_load_dwordx2 v[236:237], v17, s[8:11], s39 offen
  buffer_load_dwordx2 v[238:239], v17, s[12:15], s39 offen
  s_movk_i32 s39, 8192
  buffer_load_dwordx2 v[240:241], v17, s[8:11], s39 offen
  buffer_load_dwordx2 v[242:243], v17, s[12:15], s39 offen
  s_movk_i32 s39, 10240
  buffer_load_dwordx2 v[244:245], v17, s[8:11], s39 offen
  buffer_load_dwordx2 v[246:247], v17, s[12:15], s39 offen
  s_movk_i32 s39, 12288
  buffer_load_dwordx2 v[248:249], v17, s[8:11], s39 offen
  buffer_load_dwordx2 v[250:251], v17, s[12:15], s39 offen
  s_movk_i32 s39, 14336
  buffer_load_dwordx2 v[252:253], v17, s[8:11], s39 offen
  buffer_load_dwordx2 v[254:255], v17, s[12:15], s39 offen
  s_movk_i32 s39, 16384
  buffer_load_dwordx2 v[28:29], v17, s[8:11], s39 offen
  buffer_load_dwordx2 v[30:31], v17, s[12:15], s39 offen
  s_movk_i32 s39, 18432
  buffer_load_dwordx2 v[32:33], v17, s[8:11], s39 offen
  buffer_load_dwordx2 v[34:35], v17, s[12:15], s39 offen
  s_movk_i32 s39, 20480
  buffer_load_dwordx2 v[36:37], v17, s[8:11], s39 offen
  buffer_load_dwordx2 v[38:39], v17, s[12:15], s39 offen
  s_movk_i32 s39, 22528
  buffer_load_dwordx2 v[40:41], v17, s[8:11], s39 offen
  buffer_load_dwordx2 v[42:43], v17, s[12:15], s39 offen
  s_movk_i32 s39, 24576
  buffer_load_dwordx2 v[44:45], v17, s[8:11], s39 offen
  buffer_load_dwordx2 v[46:47], v17, s[12:15], s39 offen
  v_lshlrev_b32 v18, 1, v0
  buffer_load_ushort v48, v18, s[72:75], 0 offen offset:0
  buffer_load_ushort v49, v18, s[72:75], 0 offen offset:512
  buffer_load_ushort v50, v18, s[72:75], 0 offen offset:1024
  v_lshrrev_b32 v14, 3, v63
  v_and_b32 v15, 7, v63
  v_lshrrev_b32 v16, 4, v63
  s_movk_i32 s39, 1280
  v_mul_lo_u32 v20, v14, s39
  v_xor_b32 v18, v15, v16
  v_lshl_add_u32 v21, v18, 4, v20
  v_xor_b32 v18, 4, v18
  v_lshl_add_u32 v22, v18, 4, v20
  s_mul_i32 s26, s21, 40960
  s_add_u32 s27, s26, 10240
  s_add_u32 s28, s26, 20480
  s_add_u32 s29, s26, 30720
  s_mul_i32 s24, s20, 20480
  s_add_u32 s24, s24, 81920
  s_add_u32 m0, s24, 0
  s_nop 0
  buffer_load_dwordx4 v21, s[4:7], s26 offen lds
  s_add_u32 m0, s24, 1024
  s_nop 0
  buffer_load_dwordx4 v22, s[4:7], s27 offen lds
  s_add_u32 m0, s24, 2048
  s_nop 0
  buffer_load_dwordx4 v21, s[4:7], s28 offen lds
  s_add_u32 m0, s24, 3072
  s_nop 0
  buffer_load_dwordx4 v22, s[4:7], s29 offen lds
  s_add_u32 s4, s4, 128
  s_addc_u32 s5, s5, 0
  s_add_u32 m0, s24, 4096
  s_nop 0
  buffer_load_dwordx4 v21, s[4:7], s26 offen lds
  s_add_u32 m0, s24, 5120
  s_nop 0
  buffer_load_dwordx4 v22, s[4:7], s27 offen lds
  s_add_u32 m0, s24, 6144
  s_nop 0
  buffer_load_dwordx4 v21, s[4:7], s28 offen lds
  s_add_u32 m0, s24, 7168
  s_nop 0
  buffer_load_dwordx4 v22, s[4:7], s29 offen lds
  s_add_u32 s4, s4, 128
  s_addc_u32 s5, s5, 0
  s_add_u32 m0, s24, 8192
  s_nop 0
  buffer_load_dwordx4 v21, s[4:7], s26 offen lds
  s_add_u32 m0, s24, 9216
  s_nop 0
  buffer_load_dwordx4 v22, s[4:7], s27 offen lds
  s_add_u32 m0, s24, 10240
  s_nop 0
  buffer_load_dwordx4 v21, s[4:7], s28 offen lds
  s_add_u32 m0, s24, 11264
  s_nop 0
  buffer_load_dwordx4 v22, s[4:7], s29 offen lds
  s_add_u32 s4, s4, 128
  s_addc_u32 s5, s5, 0
  s_add_u32 m0, s24, 12288
  s_nop 0
  buffer_load_dwordx4 v21, s[4:7], s26 offen lds
  s_add_u32 m0, s24, 13312
  s_nop 0
  buffer_load_dwordx4 v22, s[4:7], s27 offen lds
  s_add_u32 m0, s24, 14336
  s_nop 0
  buffer_load_dwordx4 v21, s[4:7], s28 offen lds
  s_add_u32 m0, s24, 15360
  s_nop 0
  buffer_load_dwordx4 v22, s[4:7], s29 offen lds
  s_add_u32 s4, s4, 128
  s_addc_u32 s5, s5, 0
  s_add_u32 m0, s24, 16384
  s_nop 0
  buffer_load_dwordx4 v21, s[4:7], s26 offen lds
  s_add_u32 m0, s24, 17408
  s_nop 0
  buffer_load_dwordx4 v22, s[4:7], s27 offen lds
  s_add_u32 m0, s24, 18432
  s_nop 0
  buffer_load_dwordx4 v21, s[4:7], s28 offen lds
  s_add_u32 m0, s24, 19456
  s_nop 0
  buffer_load_dwordx4 v22, s[4:7], s29 offen lds
  s_add_u32 s4, s4, 128
  s_addc_u32 s5, s5, 0
  v_lshrrev_b32 v15, 5, v63
  s_mov_b32 s84, 52429
  v_add_u32 v17, 0, v0
  v_mul_u32_u24 v18, s84, v17
  v_lshrrev_b32 v18, 18, v18
  v_mul_u32_u24 v19, 5, v18
  v_sub_u32 v19, v17, v19
  v_bfe_u32 v24, v18, 1, 1
  v_lshlrev_b32 v24, 2, v24
  v_lshrrev_b32 v25, 1, v19
  v_xor_b32 v26, v25, v24
  v_lshlrev_b32 v26, 4, v26
  v_and_b32 v19, 1, v19
  v_lshl_add_u32 v26, v19, 3, v26
  v_lshl_add_u32 v51, v18, 7, v26
  v_add_u32 v17, 256, v0
  v_mul_u32_u24 v18, s84, v17
  v_lshrrev_b32 v18, 18, v18
  v_mul_u32_u24 v19, 5, v18
  v_sub_u32 v19, v17, v19
  v_bfe_u32 v24, v18, 1, 1
  v_lshlrev_b32 v24, 2, v24
  v_lshrrev_b32 v25, 1, v19
  v_xor_b32 v26, v25, v24
  v_lshlrev_b32 v26, 4, v26
  v_and_b32 v19, 1, v19
  v_lshl_add_u32 v26, v19, 3, v26
  v_lshl_add_u32 v52, v18, 7, v26
  v_add_u32 v17, 512, v0
  v_mul_u32_u24 v18, s84, v17
  v_lshrrev_b32 v18, 18, v18
  v_mul_u32_u24 v19, 5, v18
  v_sub_u32 v19, v17, v19
  v_bfe_u32 v24, v18, 1, 1
  v_lshlrev_b32 v24, 2, v24
  v_lshrrev_b32 v25, 1, v19
  v_xor_b32 v26, v25, v24
  v_lshlrev_b32 v26, 4, v26
  v_and_b32 v19, 1, v19
  v_lshl_add_u32 v26, v19, 3, v26
  v_lshl_add_u32 v53, v18, 7, v26
  v_add_u32 v17, 768, v0
  v_mul_u32_u24 v18, s84, v17
  v_lshrrev_b32 v18, 18, v18
  v_mul_u32_u24 v19, 5, v18
  v_sub_u32 v19, v17, v19
  v_bfe_u32 v24, v18, 1, 1
  v_lshlrev_b32 v24, 2, v24
  v_lshrrev_b32 v25, 1, v19
  v_xor_b32 v26, v25, v24
  v_lshlrev_b32 v26, 4, v26
  v_and_b32 v19, 1, v19
  v_lshl_add_u32 v26, v19, 3, v26
  v_lshl_add_u32 v54, v18, 7, v26
  v_add_u32 v17, 1024, v0
  v_mul_u32_u24 v18, s84, v17
  v_lshrrev_b32 v18, 18, v18
  v_mul_u32_u24 v19, 5, v18
  v_sub_u32 v19, v17, v19
  v_bfe_u32 v24, v18, 1, 1
  v_lshlrev_b32 v24, 2, v24
  v_lshrrev_b32 v25, 1, v19
  v_xor_b32 v26, v25, v24
  v_lshlrev_b32 v26, 4, v26
  v_and_b32 v19, 1, v19
  v_lshl_add_u32 v26, v19, 3, v26
  v_lshl_add_u32 v55, v18, 7, v26
  v_add_u32 v17, 1280, v0
  v_mul_u32_u24 v18, s84, v17
  v_lshrrev_b32 v18, 18, v18
  v_mul_u32_u24 v19, 5, v18
  v_sub_u32 v19, v17, v19
  v_bfe_u32 v24, v18, 1, 1
  v_lshlrev_b32 v24, 2, v24
  v_lshrrev_b32 v25, 1, v19
  v_xor_b32 v26, v25, v24
  v_lshlrev_b32 v26, 4, v26
  v_and_b32 v19, 1, v19
  v_lshl_add_u32 v26, v19, 3, v26
  v_lshl_add_u32 v56, v18, 7, v26
  v_add_u32 v17, 1536, v0
  v_mul_u32_u24 v18, s84, v17
  v_lshrrev_b32 v18, 18, v18
  v_mul_u32_u24 v19, 5, v18
  v_sub_u32 v19, v17, v19
  v_bfe_u32 v24, v18, 1, 1
  v_lshlrev_b32 v24, 2, v24
  v_lshrrev_b32 v25, 1, v19
  v_xor_b32 v26, v25, v24
  v_lshlrev_b32 v26, 4, v26
  v_and_b32 v19, 1, v19
  v_lshl_add_u32 v26, v19, 3, v26
  v_lshl_add_u32 v57, v18, 7, v26
  v_add_u32 v17, 1792, v0
  v_mul_u32_u24 v18, s84, v17
  v_lshrrev_b32 v18, 18, v18
  v_mul_u32_u24 v19, 5, v18
  v_sub_u32 v19, v17, v19
  v_bfe_u32 v24, v18, 1, 1
  v_lshlrev_b32 v24, 2, v24
  v_lshrrev_b32 v25, 1, v19
  v_xor_b32 v26, v25, v24
  v_lshlrev_b32 v26, 4, v26
  v_and_b32 v19, 1, v19
  v_lshl_add_u32 v26, v19, 3, v26
  v_lshl_add_u32 v58, v18, 7, v26
  v_add_u32 v17, 2048, v0
  v_mul_u32_u24 v18, s84, v17
  v_lshrrev_b32 v18, 18, v18
  v_mul_u32_u24 v19, 5, v18
  v_sub_u32 v19, v17, v19
  v_bfe_u32 v24, v18, 1, 1
  v_lshlrev_b32 v24, 2, v24
  v_lshrrev_b32 v25, 1, v19
  v_xor_b32 v26, v25, v24
  v_lshlrev_b32 v26, 4, v26
  v_and_b32 v19, 1, v19
  v_lshl_add_u32 v26, v19, 3, v26
  v_lshl_add_u32 v59, v18, 7, v26
  v_add_u32 v17, 2304, v0
  v_mul_u32_u24 v18, s84, v17
  v_lshrrev_b32 v18, 18, v18
  v_mul_u32_u24 v19, 5, v18
  v_sub_u32 v19, v17, v19
  v_bfe_u32 v24, v18, 1, 1
  v_lshlrev_b32 v24, 2, v24
  v_lshrrev_b32 v25, 1, v19
  v_xor_b32 v26, v25, v24
  v_lshlrev_b32 v26, 4, v26
  v_and_b32 v19, 1, v19
  v_lshl_add_u32 v26, v19, 3, v26
  v_lshl_add_u32 v60, v18, 7, v26
  v_add_u32 v17, 2560, v0
  v_mul_u32_u24 v18, s84, v17
  v_lshrrev_b32 v18, 18, v18
  v_mul_u32_u24 v19, 5, v18
  v_sub_u32 v19, v17, v19
  v_bfe_u32 v24, v18, 1, 1
  v_lshlrev_b32 v24, 2, v24
  v_lshrrev_b32 v25, 1, v19
  v_xor_b32 v26, v25, v24
  v_lshlrev_b32 v26, 4, v26
  v_and_b32 v19, 1, v19
  v_lshl_add_u32 v26, v19, 3, v26
  v_lshl_add_u32 v61, v18, 7, v26
  v_add_u32 v17, 2816, v0
  v_mul_u32_u24 v18, s84, v17
  v_lshrrev_b32 v18, 18, v18
  v_mul_u32_u24 v19, 5, v18
  v_sub_u32 v19, v17, v19
  v_bfe_u32 v24, v18, 1, 1
  v_lshlrev_b32 v24, 2, v24
  v_lshrrev_b32 v25, 1, v19
  v_xor_b32 v26, v25, v24
  v_lshlrev_b32 v26, 4, v26
  v_and_b32 v19, 1, v19
  v_lshl_add_u32 v26, v19, 3, v26
  v_lshl_add_u32 v62, v18, 7, v26
  v_add_u32 v17, 3072, v0
  v_mul_u32_u24 v18, s84, v17
  v_lshrrev_b32 v18, 18, v18
  v_mul_u32_u24 v19, 5, v18
  v_sub_u32 v19, v17, v19
  v_bfe_u32 v24, v18, 1, 1
  v_lshlrev_b32 v24, 2, v24
  v_lshrrev_b32 v25, 1, v19
  v_xor_b32 v26, v25, v24
  v_lshlrev_b32 v26, 4, v26
  v_and_b32 v19, 1, v19
  v_lshl_add_u32 v26, v19, 3, v26
  v_lshl_add_u32 v2, v18, 7, v26
  v_bfe_u32 v24, v0, 1, 1
  v_lshlrev_b32 v24, 2, v24
  v_xor_b32 v26, 6, v24
  v_lshlrev_b32 v26, 4, v26
  v_add_u32 v26, 8, v26
  v_lshl_add_u32 v3, v0, 7, v26
  v_add_u32 v4, 0x10000, v3
  s_waitcnt vmcnt(20)
  ds_write_b64 v51, v[224:225]
  v_xor_b32 v51, 64, v51
  ds_write_b64 v51, v[226:227]
  ds_write_b64 v52, v[228:229]
  v_xor_b32 v52, 64, v52
  ds_write_b64 v52, v[230:231]
  ds_write_b64 v53, v[232:233]
  v_xor_b32 v53, 64, v53
  ds_write_b64 v53, v[234:235]
  ds_write_b64 v54, v[236:237]
  v_xor_b32 v54, 64, v54
  ds_write_b64 v54, v[238:239]
  ds_write_b64 v55, v[240:241]
  v_xor_b32 v55, 64, v55
  ds_write_b64 v55, v[242:243]
  ds_write_b64 v56, v[244:245]
  v_xor_b32 v56, 64, v56
  ds_write_b64 v56, v[246:247]
  ds_write_b64 v57, v[248:249]
  v_xor_b32 v57, 64, v57
  ds_write_b64 v57, v[250:251]
  ds_write_b64 v58, v[252:253]
  v_xor_b32 v58, 64, v58
  ds_write_b64 v58, v[254:255]
  ds_write_b64 v59, v[28:29]
  v_xor_b32 v59, 64, v59
  ds_write_b64 v59, v[30:31]
  ds_write_b64 v60, v[32:33]
  v_xor_b32 v60, 64, v60
  ds_write_b64 v60, v[34:35]
  ds_write_b64 v61, v[36:37]
  v_xor_b32 v61, 64, v61
  ds_write_b64 v61, v[38:39]
  ds_write_b64 v62, v[40:41]
  v_xor_b32 v62, 64, v62
  ds_write_b64 v62, v[42:43]
  ds_write_b16 v3, v48
  ds_write_b16 v3, v49 offset:32768
  s_cmp_ge_u32 s20, 2
  s_cbranch_scc1 k1_kernel_kvskip
  ds_write_b64 v2, v[44:45]
  v_xor_b32 v2, 64, v2
  ds_write_b64 v2, v[46:47]
  ds_write_b16 v4, v50
k1_kernel_kvskip:
  s_waitcnt lgkmcnt(0)
  s_barrier
  v_and_b32 v14, 15, v63
  v_lshrrev_b32 v16, 2, v14
  v_and_b32 v17, 3, v14
  v_bfe_u32 v18, v63, 4, 1
  v_lshlrev_b32 v18, 1, v18
  v_lshrrev_b32 v19, 1, v17
  v_add_u32 v18, v18, v19
  v_bfe_u32 v19, v16, 1, 1
  v_lshlrev_b32 v19, 2, v19
  v_xor_b32 v18, v18, v19
  v_lshlrev_b32 v18, 4, v18
  v_and_b32 v17, 1, v17
  v_lshl_add_u32 v18, v17, 3, v18
  v_lshl_add_u32 v16, v15, 3, v16
  v_lshl_add_u32 v10, v16, 7, v18
  v_xor_b32 v11, 64, v10
  v_add_u32 v12, 0x10000, v10
  v_add_u32 v13, 0x10000, v11
  v_mov_b32 v224, 0
  v_mov_b32 v225, 0
  v_mov_b32 v226, 0
  v_mov_b32 v227, 0
  v_mov_b32 v228, 0
  v_mov_b32 v229, 0
  v_mov_b32 v230, 0
  v_mov_b32 v231, 0
  v_mov_b32 v232, 0
  v_mov_b32 v233, 0
  v_mov_b32 v234, 0
  v_mov_b32 v235, 0
  v_mov_b32 v236, 0
  v_mov_b32 v237, 0
  v_mov_b32 v238, 0
  v_mov_b32 v239, 0
  v_mov_b32 v240, 0
  v_mov_b32 v241, 0
  v_mov_b32 v242, 0
  v_mov_b32 v243, 0
  v_mov_b32 v244, 0
  v_mov_b32 v245, 0
  v_mov_b32 v246, 0
  v_mov_b32 v247, 0
  v_mov_b32 v248, 0
  v_mov_b32 v249, 0
  v_mov_b32 v250, 0
  v_mov_b32 v251, 0
  v_mov_b32 v252, 0
  v_mov_b32 v253, 0
  v_mov_b32 v254, 0
  v_mov_b32 v255, 0
  v_and_b32 v14, 31, v63
  v_lshrrev_b32 v16, 1, v14
  v_and_b32 v16, 7, v16
  v_xor_b32 v16, v16, v15
  v_lshlrev_b32 v17, 7, v14
  v_add_u32 v17, s24, v17
  v_xor_b32 v18, 0, v16
  v_lshl_add_u32 v64, v18, 4, v17
  v_xor_b32 v18, 2, v16
  v_lshl_add_u32 v65, v18, 4, v17
  v_xor_b32 v18, 4, v16
  v_lshl_add_u32 v66, v18, 4, v17
  v_xor_b32 v18, 6, v16
  v_lshl_add_u32 v67, v18, 4, v17
  s_waitcnt vmcnt(16)
  ds_read_b64_tr_b16 v[28:29], v10 offset:0
  ds_read_b64_tr_b16 v[30:31], v10 offset:512
  ds_read_b64_tr_b16 v[32:33], v11 offset:0
  ds_read_b64_tr_b16 v[34:35], v11 offset:512
  ds_read_b128 v[68:71], v64 offset:0
  ds_read_b64_tr_b16 v[36:37], v10 offset:2048
  ds_read_b64_tr_b16 v[38:39], v10 offset:2560
  ds_read_b64_tr_b16 v[40:41], v11 offset:2048
  ds_read_b64_tr_b16 v[42:43], v11 offset:2560
  ds_read_b128 v[72:75], v65 offset:0
  s_waitcnt lgkmcnt(5)
  v_mfma_f32_32x32x16_bf16 v[224:239], v[28:31], v[68:71], v[224:239]
  v_mfma_f32_32x32x16_bf16 v[240:255], v[68:71], v[32:35], v[240:255]
  ds_read_b64_tr_b16 v[28:29], v10 offset:4096
  ds_read_b64_tr_b16 v[30:31], v10 offset:4608
  ds_read_b64_tr_b16 v[32:33], v11 offset:4096
  ds_read_b64_tr_b16 v[34:35], v11 offset:4608
  ds_read_b128 v[68:71], v66 offset:0
  s_waitcnt lgkmcnt(5)
  v_mfma_f32_32x32x16_bf16 v[224:239], v[36:39], v[72:75], v[224:239]
  v_mfma_f32_32x32x16_bf16 v[240:255], v[72:75], v[40:43], v[240:255]
  ds_read_b64_tr_b16 v[36:37], v10 offset:6144
  ds_read_b64_tr_b16 v[38:39], v10 offset:6656
  ds_read_b64_tr_b16 v[40:41], v11 offset:6144
  ds_read_b64_tr_b16 v[42:43], v11 offset:6656
  ds_read_b128 v[72:75], v67 offset:0
  s_waitcnt lgkmcnt(5)
  v_mfma_f32_32x32x16_bf16 v[224:239], v[28:31], v[68:71], v[224:239]
  v_mfma_f32_32x32x16_bf16 v[240:255], v[68:71], v[32:35], v[240:255]
  s_waitcnt vmcnt(12)
  ds_read_b64_tr_b16 v[28:29], v10 offset:8192
  ds_read_b64_tr_b16 v[30:31], v10 offset:8704
  ds_read_b64_tr_b16 v[32:33], v11 offset:8192
  ds_read_b64_tr_b16 v[34:35], v11 offset:8704
  ds_read_b128 v[68:71], v64 offset:4096
  s_waitcnt lgkmcnt(5)
  s_add_u32 m0, s24, 0
  s_nop 0
  buffer_load_dwordx4 v21, s[4:7], s26 offen lds
  s_add_u32 m0, s24, 1024
  s_nop 0
  buffer_load_dwordx4 v22, s[4:7], s27 offen lds
  s_add_u32 m0, s24, 2048
  s_nop 0
  buffer_load_dwordx4 v21, s[4:7], s28 offen lds
  s_add_u32 m0, s24, 3072
  s_nop 0
  buffer_load_dwordx4 v22, s[4:7], s29 offen lds
  s_add_u32 s4, s4, 128
  s_addc_u32 s5, s5, 0
  v_mfma_f32_32x32x16_bf16 v[224:239], v[36:39], v[72:75], v[224:239]
  v_mfma_f32_32x32x16_bf16 v[240:255], v[72:75], v[40:43], v[240:255]
  ds_read_b64_tr_b16 v[36:37], v10 offset:10240
  ds_read_b64_tr_b16 v[38:39], v10 offset:10752
  ds_read_b64_tr_b16 v[40:41], v11 offset:10240
  ds_read_b64_tr_b16 v[42:43], v11 offset:10752
  ds_read_b128 v[72:75], v65 offset:4096
  s_waitcnt lgkmcnt(5)
  v_mfma_f32_32x32x16_bf16 v[224:239], v[28:31], v[68:71], v[224:239]
  v_mfma_f32_32x32x16_bf16 v[240:255], v[68:71], v[32:35], v[240:255]
  ds_read_b64_tr_b16 v[28:29], v10 offset:12288
  ds_read_b64_tr_b16 v[30:31], v10 offset:12800
  ds_read_b64_tr_b16 v[32:33], v11 offset:12288
  ds_read_b64_tr_b16 v[34:35], v11 offset:12800
  ds_read_b128 v[68:71], v66 offset:4096
  s_waitcnt lgkmcnt(5)
  v_mfma_f32_32x32x16_bf16 v[224:239], v[36:39], v[72:75], v[224:239]
  v_mfma_f32_32x32x16_bf16 v[240:255], v[72:75], v[40:43], v[240:255]
  ds_read_b64_tr_b16 v[36:37], v10 offset:14336
  ds_read_b64_tr_b16 v[38:39], v10 offset:14848
  ds_read_b64_tr_b16 v[40:41], v11 offset:14336
  ds_read_b64_tr_b16 v[42:43], v11 offset:14848
  ds_read_b128 v[72:75], v67 offset:4096
  s_waitcnt lgkmcnt(5)
  v_mfma_f32_32x32x16_bf16 v[224:239], v[28:31], v[68:71], v[224:239]
  v_mfma_f32_32x32x16_bf16 v[240:255], v[68:71], v[32:35], v[240:255]
  s_waitcnt vmcnt(12)
  ds_read_b64_tr_b16 v[28:29], v10 offset:16384
  ds_read_b64_tr_b16 v[30:31], v10 offset:16896
  ds_read_b64_tr_b16 v[32:33], v11 offset:16384
  ds_read_b64_tr_b16 v[34:35], v11 offset:16896
  ds_read_b128 v[68:71], v64 offset:8192
  s_waitcnt lgkmcnt(5)
  s_add_u32 m0, s24, 4096
  s_nop 0
  buffer_load_dwordx4 v21, s[4:7], s26 offen lds
  s_add_u32 m0, s24, 5120
  s_nop 0
  buffer_load_dwordx4 v22, s[4:7], s27 offen lds
  s_add_u32 m0, s24, 6144
  s_nop 0
  buffer_load_dwordx4 v21, s[4:7], s28 offen lds
  s_add_u32 m0, s24, 7168
  s_nop 0
  buffer_load_dwordx4 v22, s[4:7], s29 offen lds
  s_add_u32 s4, s4, 128
  s_addc_u32 s5, s5, 0
  v_mfma_f32_32x32x16_bf16 v[224:239], v[36:39], v[72:75], v[224:239]
  v_mfma_f32_32x32x16_bf16 v[240:255], v[72:75], v[40:43], v[240:255]
  ds_read_b64_tr_b16 v[36:37], v10 offset:18432
  ds_read_b64_tr_b16 v[38:39], v10 offset:18944
  ds_read_b64_tr_b16 v[40:41], v11 offset:18432
  ds_read_b64_tr_b16 v[42:43], v11 offset:18944
  ds_read_b128 v[72:75], v65 offset:8192
  s_waitcnt lgkmcnt(5)
  v_mfma_f32_32x32x16_bf16 v[224:239], v[28:31], v[68:71], v[224:239]
  v_mfma_f32_32x32x16_bf16 v[240:255], v[68:71], v[32:35], v[240:255]
  ds_read_b64_tr_b16 v[28:29], v10 offset:20480
  ds_read_b64_tr_b16 v[30:31], v10 offset:20992
  ds_read_b64_tr_b16 v[32:33], v11 offset:20480
  ds_read_b64_tr_b16 v[34:35], v11 offset:20992
  ds_read_b128 v[68:71], v66 offset:8192
  s_waitcnt lgkmcnt(5)
  v_mfma_f32_32x32x16_bf16 v[224:239], v[36:39], v[72:75], v[224:239]
  v_mfma_f32_32x32x16_bf16 v[240:255], v[72:75], v[40:43], v[240:255]
  ds_read_b64_tr_b16 v[36:37], v10 offset:22528
  ds_read_b64_tr_b16 v[38:39], v10 offset:23040
  ds_read_b64_tr_b16 v[40:41], v11 offset:22528
  ds_read_b64_tr_b16 v[42:43], v11 offset:23040
  ds_read_b128 v[72:75], v67 offset:8192
  s_waitcnt lgkmcnt(5)
  v_mfma_f32_32x32x16_bf16 v[224:239], v[28:31], v[68:71], v[224:239]
  v_mfma_f32_32x32x16_bf16 v[240:255], v[68:71], v[32:35], v[240:255]
  s_waitcnt vmcnt(12)
  ds_read_b64_tr_b16 v[28:29], v10 offset:24576
  ds_read_b64_tr_b16 v[30:31], v10 offset:25088
  ds_read_b64_tr_b16 v[32:33], v11 offset:24576
  ds_read_b64_tr_b16 v[34:35], v11 offset:25088
  ds_read_b128 v[68:71], v64 offset:12288
  s_waitcnt lgkmcnt(5)
  s_add_u32 m0, s24, 8192
  s_nop 0
  buffer_load_dwordx4 v21, s[4:7], s26 offen lds
  s_add_u32 m0, s24, 9216
  s_nop 0
  buffer_load_dwordx4 v22, s[4:7], s27 offen lds
  s_add_u32 m0, s24, 10240
  s_nop 0
  buffer_load_dwordx4 v21, s[4:7], s28 offen lds
  s_add_u32 m0, s24, 11264
  s_nop 0
  buffer_load_dwordx4 v22, s[4:7], s29 offen lds
  s_add_u32 s4, s4, 128
  s_addc_u32 s5, s5, 0
  v_mfma_f32_32x32x16_bf16 v[224:239], v[36:39], v[72:75], v[224:239]
  v_mfma_f32_32x32x16_bf16 v[240:255], v[72:75], v[40:43], v[240:255]
  ds_read_b64_tr_b16 v[36:37], v10 offset:26624
  ds_read_b64_tr_b16 v[38:39], v10 offset:27136
  ds_read_b64_tr_b16 v[40:41], v11 offset:26624
  ds_read_b64_tr_b16 v[42:43], v11 offset:27136
  ds_read_b128 v[72:75], v65 offset:12288
  s_waitcnt lgkmcnt(5)
  v_mfma_f32_32x32x16_bf16 v[224:239], v[28:31], v[68:71], v[224:239]
  v_mfma_f32_32x32x16_bf16 v[240:255], v[68:71], v[32:35], v[240:255]
  ds_read_b64_tr_b16 v[28:29], v10 offset:28672
  ds_read_b64_tr_b16 v[30:31], v10 offset:29184
  ds_read_b64_tr_b16 v[32:33], v11 offset:28672
  ds_read_b64_tr_b16 v[34:35], v11 offset:29184
  ds_read_b128 v[68:71], v66 offset:12288
  s_waitcnt lgkmcnt(5)
  v_mfma_f32_32x32x16_bf16 v[224:239], v[36:39], v[72:75], v[224:239]
  v_mfma_f32_32x32x16_bf16 v[240:255], v[72:75], v[40:43], v[240:255]
  ds_read_b64_tr_b16 v[36:37], v10 offset:30720
  ds_read_b64_tr_b16 v[38:39], v10 offset:31232
  ds_read_b64_tr_b16 v[40:41], v11 offset:30720
  ds_read_b64_tr_b16 v[42:43], v11 offset:31232
  ds_read_b128 v[72:75], v67 offset:12288
  s_waitcnt lgkmcnt(5)
  v_mfma_f32_32x32x16_bf16 v[224:239], v[28:31], v[68:71], v[224:239]
  v_mfma_f32_32x32x16_bf16 v[240:255], v[68:71], v[32:35], v[240:255]
  s_waitcnt vmcnt(12)
  ds_read_b64_tr_b16 v[28:29], v10 offset:32768
  ds_read_b64_tr_b16 v[30:31], v10 offset:33280
  ds_read_b64_tr_b16 v[32:33], v11 offset:32768
  ds_read_b64_tr_b16 v[34:35], v11 offset:33280
  ds_read_b128 v[68:71], v64 offset:16384
  s_waitcnt lgkmcnt(5)
  s_add_u32 m0, s24, 12288
  s_nop 0
  buffer_load_dwordx4 v21, s[4:7], s26 offen lds
  s_add_u32 m0, s24, 13312
  s_nop 0
  buffer_load_dwordx4 v22, s[4:7], s27 offen lds
  s_add_u32 m0, s24, 14336
  s_nop 0
  buffer_load_dwordx4 v21, s[4:7], s28 offen lds
  s_add_u32 m0, s24, 15360
  s_nop 0
  buffer_load_dwordx4 v22, s[4:7], s29 offen lds
  s_add_u32 s4, s4, 128
  s_addc_u32 s5, s5, 0
  v_mfma_f32_32x32x16_bf16 v[224:239], v[36:39], v[72:75], v[224:239]
  v_mfma_f32_32x32x16_bf16 v[240:255], v[72:75], v[40:43], v[240:255]
  ds_read_b64_tr_b16 v[36:37], v10 offset:34816
  ds_read_b64_tr_b16 v[38:39], v10 offset:35328
  ds_read_b64_tr_b16 v[40:41], v11 offset:34816
  ds_read_b64_tr_b16 v[42:43], v11 offset:35328
  ds_read_b128 v[72:75], v65 offset:16384
  s_waitcnt lgkmcnt(5)
  v_mfma_f32_32x32x16_bf16 v[224:239], v[28:31], v[68:71], v[224:239]
  v_mfma_f32_32x32x16_bf16 v[240:255], v[68:71], v[32:35], v[240:255]
  ds_read_b64_tr_b16 v[28:29], v10 offset:36864
  ds_read_b64_tr_b16 v[30:31], v10 offset:37376
  ds_read_b64_tr_b16 v[32:33], v11 offset:36864
  ds_read_b64_tr_b16 v[34:35], v11 offset:37376
  ds_read_b128 v[68:71], v66 offset:16384
  s_waitcnt lgkmcnt(5)
  v_mfma_f32_32x32x16_bf16 v[224:239], v[36:39], v[72:75], v[224:239]
  v_mfma_f32_32x32x16_bf16 v[240:255], v[72:75], v[40:43], v[240:255]
  ds_read_b64_tr_b16 v[36:37], v10 offset:38912
  ds_read_b64_tr_b16 v[38:39], v10 offset:39424
  ds_read_b64_tr_b16 v[40:41], v11 offset:38912
  ds_read_b64_tr_b16 v[42:43], v11 offset:39424
  ds_read_b128 v[72:75], v67 offset:16384
  s_waitcnt lgkmcnt(5)
  v_mfma_f32_32x32x16_bf16 v[224:239], v[28:31], v[68:71], v[224:239]
  v_mfma_f32_32x32x16_bf16 v[240:255], v[68:71], v[32:35], v[240:255]
  s_waitcnt vmcnt(12)
  ds_read_b64_tr_b16 v[28:29], v10 offset:40960
  ds_read_b64_tr_b16 v[30:31], v10 offset:41472
  ds_read_b64_tr_b16 v[32:33], v11 offset:40960
  ds_read_b64_tr_b16 v[34:35], v11 offset:41472
  ds_read_b128 v[68:71], v64 offset:0
  s_waitcnt lgkmcnt(5)
  s_add_u32 m0, s24, 16384
  s_nop 0
  buffer_load_dwordx4 v21, s[4:7], s26 offen lds
  s_add_u32 m0, s24, 17408
  s_nop 0
  buffer_load_dwordx4 v22, s[4:7], s27 offen lds
  s_add_u32 m0, s24, 18432
  s_nop 0
  buffer_load_dwordx4 v21, s[4:7], s28 offen lds
  s_add_u32 m0, s24, 19456
  s_nop 0
  buffer_load_dwordx4 v22, s[4:7], s29 offen lds
  s_add_u32 s4, s4, 128
  s_addc_u32 s5, s5, 0
  v_mfma_f32_32x32x16_bf16 v[224:239], v[36:39], v[72:75], v[224:239]
  v_mfma_f32_32x32x16_bf16 v[240:255], v[72:75], v[40:43], v[240:255]
  ds_read_b64_tr_b16 v[36:37], v10 offset:43008
  ds_read_b64_tr_b16 v[38:39], v10 offset:43520
  ds_read_b64_tr_b16 v[40:41], v11 offset:43008
  ds_read_b64_tr_b16 v[42:43], v11 offset:43520
  ds_read_b128 v[72:75], v65 offset:0
  s_waitcnt lgkmcnt(5)
  v_mfma_f32_32x32x16_bf16 v[224:239], v[28:31], v[68:71], v[224:239]
  v_mfma_f32_32x32x16_bf16 v[240:255], v[68:71], v[32:35], v[240:255]
  ds_read_b64_tr_b16 v[28:29], v10 offset:45056
  ds_read_b64_tr_b16 v[30:31], v10 offset:45568
  ds_read_b64_tr_b16 v[32:33], v11 offset:45056
  ds_read_b64_tr_b16 v[34:35], v11 offset:45568
  ds_read_b128 v[68:71], v66 offset:0
  s_waitcnt lgkmcnt(5)
  v_mfma_f32_32x32x16_bf16 v[224:239], v[36:39], v[72:75], v[224:239]
  v_mfma_f32_32x32x16_bf16 v[240:255], v[72:75], v[40:43], v[240:255]
  ds_read_b64_tr_b16 v[36:37], v10 offset:47104
  ds_read_b64_tr_b16 v[38:39], v10 offset:47616
  ds_read_b64_tr_b16 v[40:41], v11 offset:47104
  ds_read_b64_tr_b16 v[42:43], v11 offset:47616
  ds_read_b128 v[72:75], v67 offset:0
  s_waitcnt lgkmcnt(5)
  v_mfma_f32_32x32x16_bf16 v[224:239], v[28:31], v[68:71], v[224:239]
  v_mfma_f32_32x32x16_bf16 v[240:255], v[68:71], v[32:35], v[240:255]
  s_waitcnt vmcnt(12)
  ds_read_b64_tr_b16 v[28:29], v10 offset:49152
  ds_read_b64_tr_b16 v[30:31], v10 offset:49664
  ds_read_b64_tr_b16 v[32:33], v11 offset:49152
  ds_read_b64_tr_b16 v[34:35], v11 offset:49664
  ds_read_b128 v[68:71], v64 offset:4096
  s_waitcnt lgkmcnt(5)
  v_mfma_f32_32x32x16_bf16 v[224:239], v[36:39], v[72:75], v[224:239]
  v_mfma_f32_32x32x16_bf16 v[240:255], v[72:75], v[40:43], v[240:255]
  ds_read_b64_tr_b16 v[36:37], v10 offset:51200
  ds_read_b64_tr_b16 v[38:39], v10 offset:51712
  ds_read_b64_tr_b16 v[40:41], v11 offset:51200
  ds_read_b64_tr_b16 v[42:43], v11 offset:51712
  ds_read_b128 v[72:75], v65 offset:4096
  s_waitcnt lgkmcnt(5)
  v_mfma_f32_32x32x16_bf16 v[224:239], v[28:31], v[68:71], v[224:239]
  v_mfma_f32_32x32x16_bf16 v[240:255], v[68:71], v[32:35], v[240:255]
  ds_read_b64_tr_b16 v[28:29], v10 offset:53248
  ds_read_b64_tr_b16 v[30:31], v10 offset:53760
  ds_read_b64_tr_b16 v[32:33], v11 offset:53248
  ds_read_b64_tr_b16 v[34:35], v11 offset:53760
  ds_read_b128 v[68:71], v66 offset:4096
  s_waitcnt lgkmcnt(5)
  v_mfma_f32_32x32x16_bf16 v[224:239], v[36:39], v[72:75], v[224:239]
  v_mfma_f32_32x32x16_bf16 v[240:255], v[72:75], v[40:43], v[240:255]
  ds_read_b64_tr_b16 v[36:37], v10 offset:55296
  ds_read_b64_tr_b16 v[38:39], v10 offset:55808
  ds_read_b64_tr_b16 v[40:41], v11 offset:55296
  ds_read_b64_tr_b16 v[42:43], v11 offset:55808
  ds_read_b128 v[72:75], v67 offset:4096
  s_waitcnt lgkmcnt(5)
  v_mfma_f32_32x32x16_bf16 v[224:239], v[28:31], v[68:71], v[224:239]
  v_mfma_f32_32x32x16_bf16 v[240:255], v[68:71], v[32:35], v[240:255]
  s_waitcnt vmcnt(8)
  ds_read_b64_tr_b16 v[28:29], v10 offset:57344
  ds_read_b64_tr_b16 v[30:31], v10 offset:57856
  ds_read_b64_tr_b16 v[32:33], v11 offset:57344
  ds_read_b64_tr_b16 v[34:35], v11 offset:57856
  ds_read_b128 v[68:71], v64 offset:8192
  s_waitcnt lgkmcnt(5)
  v_mfma_f32_32x32x16_bf16 v[224:239], v[36:39], v[72:75], v[224:239]
  v_mfma_f32_32x32x16_bf16 v[240:255], v[72:75], v[40:43], v[240:255]
  ds_read_b64_tr_b16 v[36:37], v10 offset:59392
  ds_read_b64_tr_b16 v[38:39], v10 offset:59904
  ds_read_b64_tr_b16 v[40:41], v11 offset:59392
  ds_read_b64_tr_b16 v[42:43], v11 offset:59904
  ds_read_b128 v[72:75], v65 offset:8192
  s_waitcnt lgkmcnt(5)
  v_mfma_f32_32x32x16_bf16 v[224:239], v[28:31], v[68:71], v[224:239]
  v_mfma_f32_32x32x16_bf16 v[240:255], v[68:71], v[32:35], v[240:255]
  ds_read_b64_tr_b16 v[28:29], v10 offset:61440
  ds_read_b64_tr_b16 v[30:31], v10 offset:61952
  ds_read_b64_tr_b16 v[32:33], v11 offset:61440
  ds_read_b64_tr_b16 v[34:35], v11 offset:61952
  ds_read_b128 v[68:71], v66 offset:8192
  s_waitcnt lgkmcnt(5)
  v_mfma_f32_32x32x16_bf16 v[224:239], v[36:39], v[72:75], v[224:239]
  v_mfma_f32_32x32x16_bf16 v[240:255], v[72:75], v[40:43], v[240:255]
  ds_read_b64_tr_b16 v[36:37], v10 offset:63488
  ds_read_b64_tr_b16 v[38:39], v10 offset:64000
  ds_read_b64_tr_b16 v[40:41], v11 offset:63488
  ds_read_b64_tr_b16 v[42:43], v11 offset:64000
  ds_read_b128 v[72:75], v67 offset:8192
  s_waitcnt lgkmcnt(5)
  v_mfma_f32_32x32x16_bf16 v[224:239], v[28:31], v[68:71], v[224:239]
  v_mfma_f32_32x32x16_bf16 v[240:255], v[68:71], v[32:35], v[240:255]
  s_waitcnt vmcnt(4)
  ds_read_b64_tr_b16 v[28:29], v12 offset:0
  ds_read_b64_tr_b16 v[30:31], v12 offset:512
  ds_read_b64_tr_b16 v[32:33], v13 offset:0
  ds_read_b64_tr_b16 v[34:35], v13 offset:512
  ds_read_b128 v[68:71], v64 offset:12288
  s_waitcnt lgkmcnt(5)
  v_mfma_f32_32x32x16_bf16 v[224:239], v[36:39], v[72:75], v[224:239]
  v_mfma_f32_32x32x16_bf16 v[240:255], v[72:75], v[40:43], v[240:255]
  ds_read_b64_tr_b16 v[36:37], v12 offset:2048
  ds_read_b64_tr_b16 v[38:39], v12 offset:2560
  ds_read_b64_tr_b16 v[40:41], v13 offset:2048
  ds_read_b64_tr_b16 v[42:43], v13 offset:2560
  ds_read_b128 v[72:75], v65 offset:12288
  s_waitcnt lgkmcnt(5)
  v_mfma_f32_32x32x16_bf16 v[224:239], v[28:31], v[68:71], v[224:239]
  v_mfma_f32_32x32x16_bf16 v[240:255], v[68:71], v[32:35], v[240:255]
  ds_read_b64_tr_b16 v[28:29], v12 offset:4096
  ds_read_b64_tr_b16 v[30:31], v12 offset:4608
  ds_read_b64_tr_b16 v[32:33], v13 offset:4096
  ds_read_b64_tr_b16 v[34:35], v13 offset:4608
  ds_read_b128 v[68:71], v66 offset:12288
  s_waitcnt lgkmcnt(5)
  v_mfma_f32_32x32x16_bf16 v[224:239], v[36:39], v[72:75], v[224:239]
  v_mfma_f32_32x32x16_bf16 v[240:255], v[72:75], v[40:43], v[240:255]
  ds_read_b64_tr_b16 v[36:37], v12 offset:6144
  ds_read_b64_tr_b16 v[38:39], v12 offset:6656
  ds_read_b64_tr_b16 v[40:41], v13 offset:6144
  ds_read_b64_tr_b16 v[42:43], v13 offset:6656
  ds_read_b128 v[72:75], v67 offset:12288
  s_waitcnt lgkmcnt(5)
  v_mfma_f32_32x32x16_bf16 v[224:239], v[28:31], v[68:71], v[224:239]
  v_mfma_f32_32x32x16_bf16 v[240:255], v[68:71], v[32:35], v[240:255]
  s_waitcnt vmcnt(0)
  ds_read_b64_tr_b16 v[28:29], v12 offset:8192
  ds_read_b64_tr_b16 v[30:31], v12 offset:8704
  ds_read_b64_tr_b16 v[32:33], v13 offset:8192
  ds_read_b64_tr_b16 v[34:35], v13 offset:8704
  ds_read_b128 v[68:71], v64 offset:16384
  s_waitcnt lgkmcnt(5)
  v_mfma_f32_32x32x16_bf16 v[224:239], v[36:39], v[72:75], v[224:239]
  v_mfma_f32_32x32x16_bf16 v[240:255], v[72:75], v[40:43], v[240:255]
  ds_read_b64_tr_b16 v[36:37], v12 offset:10240
  ds_read_b64_tr_b16 v[38:39], v12 offset:10752
  ds_read_b64_tr_b16 v[40:41], v13 offset:10240
  ds_read_b64_tr_b16 v[42:43], v13 offset:10752
  ds_read_b128 v[72:75], v65 offset:16384
  s_waitcnt lgkmcnt(5)
  v_mfma_f32_32x32x16_bf16 v[224:239], v[28:31], v[68:71], v[224:239]
  v_mfma_f32_32x32x16_bf16 v[240:255], v[68:71], v[32:35], v[240:255]
  ds_read_b64_tr_b16 v[28:29], v12 offset:12288
  ds_read_b64_tr_b16 v[30:31], v12 offset:12800
  ds_read_b64_tr_b16 v[32:33], v13 offset:12288
  ds_read_b64_tr_b16 v[34:35], v13 offset:12800
  ds_read_b128 v[68:71], v66 offset:16384
  s_waitcnt lgkmcnt(5)
  v_mfma_f32_32x32x16_bf16 v[224:239], v[36:39], v[72:75], v[224:239]
  v_mfma_f32_32x32x16_bf16 v[240:255], v[72:75], v[40:43], v[240:255]
  ds_read_b64_tr_b16 v[36:37], v12 offset:14336
  ds_read_b64_tr_b16 v[38:39], v12 offset:14848
  ds_read_b64_tr_b16 v[40:41], v13 offset:14336
  ds_read_b64_tr_b16 v[42:43], v13 offset:14848
  ds_read_b128 v[72:75], v67 offset:16384
  s_waitcnt lgkmcnt(5)
  v_mfma_f32_32x32x16_bf16 v[224:239], v[28:31], v[68:71], v[224:239]
  v_mfma_f32_32x32x16_bf16 v[240:255], v[68:71], v[32:35], v[240:255]
  s_waitcnt lgkmcnt(0)
  v_mfma_f32_32x32x16_bf16 v[224:239], v[36:39], v[72:75], v[224:239]
  v_mfma_f32_32x32x16_bf16 v[240:255], v[72:75], v[40:43], v[240:255]
  s_nop 15
  s_mul_i32 s78, s21, 3584
  s_add_u32 s78, s78, 2621440
  v_lshlrev_b32 v16, 4, v63
  v_cvt_pk_bf16_f32 v44, v224, v225
  v_cvt_pk_bf16_f32 v45, v226, v227
  v_cvt_pk_bf16_f32 v46, v228, v229
  v_cvt_pk_bf16_f32 v47, v230, v231
  v_cvt_pk_bf16_f32 v48, v232, v233
  v_cvt_pk_bf16_f32 v49, v234, v235
  buffer_store_dwordx4 v[44:47], v16, s[16:19], s78 offen sc1
  v_mul_f32 v20, v224, v224
  v_fmac_f32 v20, v225, v225
  v_fmac_f32 v20, v226, v226
  v_fmac_f32 v20, v227, v227
  v_fmac_f32 v20, v228, v228
  v_fmac_f32 v20, v229, v229
  v_fmac_f32 v20, v230, v230
  v_fmac_f32 v20, v231, v231
  v_mul_f32 v21, v232, v232
  v_fmac_f32 v21, v233, v233
  v_fmac_f32 v21, v234, v234
  v_fmac_f32 v21, v235, v235
  v_cmp_gt_u32 vcc, 32, v63
  s_nop 1
  v_cndmask_b32 v21, 0, v21, vcc
  v_add_f32 v20, v20, v21
  v_mov_b32 v21, v20
  s_nop 1
  v_permlane32_swap_b32 v20, v21
  s_nop 1
  v_add_f32 v20, v20, v21
  ds_swizzle_b32 v21, v20 offset:1055
  s_waitcnt lgkmcnt(0)
  v_max_f32 v20, v20, v21
  ds_swizzle_b32 v21, v20 offset:2079
  s_waitcnt lgkmcnt(0)
  v_max_f32 v20, v20, v21
  ds_swizzle_b32 v21, v20 offset:4127
  s_waitcnt lgkmcnt(0)
  v_max_f32 v20, v20, v21
  ds_swizzle_b32 v21, v20 offset:8223
  s_waitcnt lgkmcnt(0)
  v_max_f32 v20, v20, v21
  ds_swizzle_b32 v21, v20 offset:16415
  s_waitcnt lgkmcnt(0)
  v_max_f32 v20, v20, v21
  v_lshlrev_b32 v17, 3, v63
  v_cmp_gt_u32 vcc, 32, v63
  v_mov_b32 v22, 0x3f803f80
  v_mov_b32 v23, 0x00003f80
  v_cndmask_b32 v48, v22, v48, vcc
  v_cndmask_b32 v49, v23, v49, vcc
  buffer_store_dwordx2 v[48:49], v17, s[16:19], s78 offen offset:3072 sc1
  s_lshl_b32 s79, s21, 2
  s_add_u32 s79, s79, 2850816
  v_mov_b32 v17, 0
  v_cmp_eq_u32 vcc, 0, v63
  s_and_saveexec_b64 s[86:87], vcc
  buffer_store_dword v20, v17, s[16:19], s79 offen sc1
  s_mov_b64 exec, s[86:87]
  v_and_b32 v14, 31, v63
  s_lshl_b32 s79, s21, 7
  s_add_u32 s79, s79, 2854912
  v_lshlrev_b32 v17, 4, v15
  v_cmp_eq_u32 vcc, 20, v14
  s_and_saveexec_b64 s[86:87], vcc
  buffer_store_dwordx4 v[240:243], v17, s[16:19], s79 offen offset:0 sc1
  buffer_store_dwordx4 v[244:247], v17, s[16:19], s79 offen offset:32 sc1
  buffer_store_dwordx4 v[248:251], v17, s[16:19], s79 offen offset:64 sc1
  buffer_store_dwordx4 v[252:255], v17, s[16:19], s79 offen offset:96 sc1
  s_nop 1
  v_mov_b32 v240, 1.0
  v_mov_b32 v241, 1.0
  v_mov_b32 v242, 1.0
  v_mov_b32 v243, 1.0
  v_mov_b32 v244, 1.0
  v_mov_b32 v245, 1.0
  v_mov_b32 v246, 1.0
  v_mov_b32 v247, 1.0
  v_mov_b32 v248, 1.0
  v_mov_b32 v249, 1.0
  v_mov_b32 v250, 1.0
  v_mov_b32 v251, 1.0
  v_mov_b32 v252, 1.0
  v_mov_b32 v253, 1.0
  v_mov_b32 v254, 1.0
  v_mov_b32 v255, 1.0
  s_mov_b64 exec, s[86:87]
  v_cmp_lt_u32 vcc, 20, v14
  s_and_saveexec_b64 s[86:87], vcc
  v_mov_b32 v240, 0
  v_mov_b32 v241, 0
  v_mov_b32 v242, 0
  v_mov_b32 v243, 0
  v_mov_b32 v244, 0
  v_mov_b32 v245, 0
  v_mov_b32 v246, 0
  v_mov_b32 v247, 0
  v_mov_b32 v248, 0
  v_mov_b32 v249, 0
  v_mov_b32 v250, 0
  v_mov_b32 v251, 0
  v_mov_b32 v252, 0
  v_mov_b32 v253, 0
  v_mov_b32 v254, 0
  v_mov_b32 v255, 0
  s_mov_b64 exec, s[86:87]
  v_cvt_pk_bf16_f32 v52, v240, v241
  v_cvt_pk_bf16_f32 v53, v242, v243
  v_cvt_pk_bf16_f32 v54, v244, v245
  v_cvt_pk_bf16_f32 v55, v246, v247
  v_cvt_pk_bf16_f32 v56, v248, v249
  v_cvt_pk_bf16_f32 v57, v250, v251
  v_cvt_pk_bf16_f32 v58, v252, v253
  v_cvt_pk_bf16_f32 v59, v254, v255
  buffer_store_dwordx4 v[52:55], v16, s[16:19], s78 offen offset:1024 sc1
  buffer_store_dwordx4 v[56:59], v16, s[16:19], s78 offen offset:2048 sc1
  s_waitcnt vmcnt(0) lgkmcnt(0)
  s_barrier
k1_kernel_xform:
  s_cmp_lt_u32 s21, 64
  s_cselect_b32 s24, 64, 32
  s_movk_i32 s26, 340
  s_cselect_b32 s26, 128, s26
  s_add_u32 s25, s21, 64
  s_cmp_lt_u32 s21, 64
  s_cselect_b32 s25, s21, s25
  s_mov_b32 s8, s56
  s_and_b32 s9, s57, 0xffff
  s_mov_b32 s10, 1966080
  s_mov_b32 s11, 0x20000
  s_mov_b32 s12, s48
  s_and_b32 s13, s49, 0xffff
  s_mov_b32 s14, 819200
  s_mov_b32 s15, 0x20000
  s_lshl_b32 s27, s20, 15
  v_lshrrev_b32 v14, 4, v63
  v_and_b32 v15, 15, v63
  s_movk_i32 s39, 1280
  v_mul_lo_u32 v16, v14, s39
  v_lshl_add_u32 v16, v15, 4, v16
  v_lshrrev_b32 v17, 4, v63
  v_and_b32 v18, 15, v63
  v_lshrrev_b32 v19, 2, v18
  v_and_b32 v18, 3, v18
  v_lshl_add_u32 v17, v17, 3, v19
  v_lshlrev_b32 v17, 8, v17
  v_lshl_add_u32 v17, v18, 3, v17
  v_add_u32 v17, s27, v17
  v_lshlrev_b32 v18, 4, v63
xf_loop_1:
  s_cmp_ge_u32 s25, s26
  s_cbranch_scc1 xf_done_2
  s_mov_b32 s36, s25
  s_mov_b32 s37, 0
  s_mov_b32 s38, s27
xf_iss_5:
  s_cmp_lt_u32 s25, 240
  s_cbranch_scc1 xf_w2_3
  s_sub_u32 s28, s25, 240
  s_mul_i32 s29, s28, 52429
  s_lshr_b32 s29, s29, 18
  s_mul_i32 s30, s29, 5
  s_sub_u32 s30, s28, s30
  s_lshl_b32 s31, s29, 2
  s_add_u32 s31, s31, 0
  s_mul_i32 s32, s31, 52429
  s_lshr_b32 s32, s32, 18
  s_mul_i32 s33, s32, 5
  s_sub_u32 s33, s31, s33
  s_lshr_b32 s34, s33, 1
  s_mul_i32 s34, s34, 20
  s_and_b32 s35, s33, 1
  s_lshl_b32 s35, s35, 2
  s_add_u32 s34, s34, s35
  s_cmp_eq_u32 s33, 4
  s_cselect_b32 s34, 16, s34
  s_cselect_b32 s35, 20, 8
  s_mul_i32 s32, s32, 40
  s_add_u32 s34, s34, s32
  s_add_u32 s35, s35, s34
  s_mul_i32 s64, s34, 1280
  s_mul_i32 s65, s35, 1280
  s_lshl_b32 s31, s29, 2
  s_add_u32 s31, s31, 1
  s_mul_i32 s32, s31, 52429
  s_lshr_b32 s32, s32, 18
  s_mul_i32 s33, s32, 5
  s_sub_u32 s33, s31, s33
  s_lshr_b32 s34, s33, 1
  s_mul_i32 s34, s34, 20
  s_and_b32 s35, s33, 1
  s_lshl_b32 s35, s35, 2
  s_add_u32 s34, s34, s35
  s_cmp_eq_u32 s33, 4
  s_cselect_b32 s34, 16, s34
  s_cselect_b32 s35, 20, 8
  s_mul_i32 s32, s32, 40
  s_add_u32 s34, s34, s32
  s_add_u32 s35, s35, s34
  s_mul_i32 s66, s34, 1280
  s_mul_i32 s67, s35, 1280
  s_lshl_b32 s31, s29, 2
  s_add_u32 s31, s31, 2
  s_mul_i32 s32, s31, 52429
  s_lshr_b32 s32, s32, 18
  s_mul_i32 s33, s32, 5
  s_sub_u32 s33, s31, s33
  s_lshr_b32 s34, s33, 1
  s_mul_i32 s34, s34, 20
  s_and_b32 s35, s33, 1
  s_lshl_b32 s35, s35, 2
  s_add_u32 s34, s34, s35
  s_cmp_eq_u32 s33, 4
  s_cselect_b32 s34, 16, s34
  s_cselect_b32 s35, 20, 8
  s_mul_i32 s32, s32, 40
  s_add_u32 s34, s34, s32
  s_add_u32 s35, s35, s34
  s_mul_i32 s68, s34, 1280
  s_mul_i32 s69, s35, 1280
  s_lshl_b32 s31, s29, 2
  s_add_u32 s31, s31, 3
  s_mul_i32 s32, s31, 52429
  s_lshr_b32 s32, s32, 18
  s_mul_i32 s33, s32, 5
  s_sub_u32 s33, s31, s33
  s_lshr_b32 s34, s33, 1
  s_mul_i32 s34, s34, 20
  s_and_b32 s35, s33, 1
  s_lshl_b32 s35, s35, 2
  s_add_u32 s34, s34, s35
  s_cmp_eq_u32 s33, 4
  s_cselect_b32 s34, 16, s34
  s_cselect_b32 s35, 20, 8
  s_mul_i32 s32, s32, 40
  s_add_u32 s34, s34, s32
  s_add_u32 s35, s35, s34
  s_mul_i32 s70, s34, 1280
  s_mul_i32 s71, s35, 1280
  s_mov_b32 s72, s12
  s_mov_b32 s73, s13
  s_mov_b32 s74, s14
  s_mov_b32 s75, 0x20000
  s_branch xf_go_4
xf_w2_3:
  s_mul_i32 s29, s25, 52429
  s_lshr_b32 s29, s29, 18
  s_mul_i32 s30, s29, 5
  s_sub_u32 s30, s25, s30
  s_lshl_b32 s31, s29, 5
  s_add_u32 s34, s31, 0
  s_mul_i32 s64, s34, 1280
  s_add_u32 s65, s64, 10240
  s_add_u32 s34, s31, 16
  s_mul_i32 s66, s34, 1280
  s_add_u32 s67, s66, 10240
  s_add_u32 s34, s31, 4
  s_mul_i32 s68, s34, 1280
  s_add_u32 s69, s68, 10240
  s_add_u32 s34, s31, 20
  s_mul_i32 s70, s34, 1280
  s_add_u32 s71, s70, 10240
  s_mov_b32 s72, s8
  s_mov_b32 s73, s9
  s_mov_b32 s74, s10
  s_mov_b32 s75, 0x20000
xf_go_4:
  s_lshl_b32 s31, s30, 8
  s_add_u32 s64, s64, s31
  s_add_u32 m0, s38, 0
  s_nop 0
  buffer_load_dwordx4 v16, s[72:75], s64 offen lds
  s_add_u32 s65, s65, s31
  s_add_u32 m0, s38, 1024
  s_nop 0
  buffer_load_dwordx4 v16, s[72:75], s65 offen lds
  s_add_u32 s66, s66, s31
  s_add_u32 m0, s38, 2048
  s_nop 0
  buffer_load_dwordx4 v16, s[72:75], s66 offen lds
  s_add_u32 s67, s67, s31
  s_add_u32 m0, s38, 3072
  s_nop 0
  buffer_load_dwordx4 v16, s[72:75], s67 offen lds
  s_add_u32 s68, s68, s31
  s_add_u32 m0, s38, 4096
  s_nop 0
  buffer_load_dwordx4 v16, s[72:75], s68 offen lds
  s_add_u32 s69, s69, s31
  s_add_u32 m0, s38, 5120
  s_nop 0
  buffer_load_dwordx4 v16, s[72:75], s69 offen lds
  s_add_u32 s70, s70, s31
  s_add_u32 m0, s38, 6144
  s_nop 0
  buffer_load_dwordx4 v16, s[72:75], s70 offen lds
  s_add_u32 s71, s71, s31
  s_add_u32 m0, s38, 7168
  s_nop 0
  buffer_load_dwordx4 v16, s[72:75], s71 offen lds
  s_add_u32 s38, s38, 8192
  s_add_u32 s37, s37, 1
  s_add_u32 s25, s25, s24
  s_cmp_ge_u32 s25, s26
  s_cbranch_scc1 xf_issd_6
  s_cmp_lt_u32 s37, 4
  s_cbranch_scc1 xf_iss_5
xf_issd_6:
  s_waitcnt vmcnt(0)
  v_mov_b32 v19, v17
xf_pr_7:
  ds_read_b64_tr_b16 v[64:65], v19 offset:0
  ds_read_b64_tr_b16 v[66:67], v19 offset:1024
  ds_read_b64_tr_b16 v[68:69], v19 offset:32
  ds_read_b64_tr_b16 v[70:71], v19 offset:1056
  ds_read_b64_tr_b16 v[72:73], v19 offset:64
  ds_read_b64_tr_b16 v[74:75], v19 offset:1088
  ds_read_b64_tr_b16 v[76:77], v19 offset:96
  ds_read_b64_tr_b16 v[78:79], v19 offset:1120
  ds_read_b64_tr_b16 v[80:81], v19 offset:128
  ds_read_b64_tr_b16 v[82:83], v19 offset:1152
  ds_read_b64_tr_b16 v[84:85], v19 offset:160
  ds_read_b64_tr_b16 v[86:87], v19 offset:1184
  ds_read_b64_tr_b16 v[88:89], v19 offset:192
  ds_read_b64_tr_b16 v[90:91], v19 offset:1216
  ds_read_b64_tr_b16 v[92:93], v19 offset:224
  ds_read_b64_tr_b16 v[94:95], v19 offset:1248
  s_lshl_b32 s76, s36, 13
  s_add_u32 s76, s76, 12582912
  s_waitcnt lgkmcnt(14)
  s_add_u32 s77, s76, 0
  buffer_store_dwordx4 v[64:67], v18, s[16:19], s77 offen sc1
  s_waitcnt lgkmcnt(12)
  s_add_u32 s77, s76, 1024
  buffer_store_dwordx4 v[68:71], v18, s[16:19], s77 offen sc1
  s_waitcnt lgkmcnt(10)
  s_add_u32 s77, s76, 2048
  buffer_store_dwordx4 v[72:75], v18, s[16:19], s77 offen sc1
  s_waitcnt lgkmcnt(8)
  s_add_u32 s77, s76, 3072
  buffer_store_dwordx4 v[76:79], v18, s[16:19], s77 offen sc1
  s_waitcnt lgkmcnt(6)
  s_add_u32 s77, s76, 4096
  buffer_store_dwordx4 v[80:83], v18, s[16:19], s77 offen sc1
  s_waitcnt lgkmcnt(4)
  s_add_u32 s77, s76, 5120
  buffer_store_dwordx4 v[84:87], v18, s[16:19], s77 offen sc1
  s_waitcnt lgkmcnt(2)
  s_add_u32 s77, s76, 6144
  buffer_store_dwordx4 v[88:91], v18, s[16:19], s77 offen sc1
  s_waitcnt lgkmcnt(0)
  s_add_u32 s77, s76, 7168
  buffer_store_dwordx4 v[92:95], v18, s[16:19], s77 offen sc1
  v_add_u32 v19, 8192, v19
  s_add_u32 s36, s36, s24
  s_sub_u32 s37, s37, 1
  s_cmp_gt_u32 s37, 0
  s_cbranch_scc1 xf_pr_7
  s_branch xf_loop_1
xf_done_2:
k1_kernel_fin:
k1_kernel_end:
  s_endpgm

.globl kd_kernel
.p2align 8
.type kd_kernel,@function
kd_kernel:

  s_cmp_ge_u32 s2, 256
  s_cbranch_scc1 kd_kernel_end
  s_load_dwordx2 s[60:61], s[0:1], 96
  v_lshrrev_b32 v4, 6, v0
  v_and_b32 v1, 63, v0
  v_readfirstlane_b32 s20, v4
  s_cmp_ge_u32 s20, 4
  s_cbranch_scc1 kd_kernel_gemm
  s_and_b32 s21, s2, 7
  s_mov_b32 s58, 0x07060302
  s_lshr_b32 s22, s2, 3
  v_lshlrev_b32 v2, 4, v1
  v_and_b32 v5, 31, v1
  v_lshlrev_b32 v3, 3, v5
  v_lshrrev_b32 v6, 5, v1
  v_lshlrev_b32 v7, 28, v6
  v_add_u32 v7, v7, v3
  v_lshlrev_b32 v4, 2, v5
  s_and_b32 s23, s20, 1
  s_lshr_b32 s24, s20, 1
  s_lshl_b32 s25, s22, 1
  s_add_u32 s25, s25, s23
  s_lshl_b32 s26, s21, 8
  s_add_u32 s26, s26, s25
  s_mul_i32 s26, s26, 1280
  s_add_u32 s26, s26, 0
  s_lshl_b32 s30, s24, 5
  s_mul_i32 s30, s30, 3584
  s_add_u32 s30, s30, 2621440
  s_mov_b32 s31, 2850816
  v_lshlrev_b32 v8, 2, v1
  v_lshlrev_b32 v241, 3, v1
  s_waitcnt lgkmcnt(0)
  s_mov_b32 s16, s60
  s_and_b32 s17, s61, 0xffff
  s_mov_b32 s18, 23068672
  s_mov_b32 s19, 0x20000
  buffer_load_dword v216, v8, s[16:19], s31 offen
  buffer_load_dwordx2 v[8:9], v241, s[16:19], s26 offen
  buffer_load_dwordx2 v[10:11], v241, s[16:19], s26 offen offset:512
  buffer_load_dwordx2 v[24:25], v7, s[16:19], s26 offen offset:1024
  s_add_u32 s26, s26, 81920
  buffer_load_dwordx2 v[12:13], v241, s[16:19], s26 offen
  buffer_load_dwordx2 v[14:15], v241, s[16:19], s26 offen offset:512
  buffer_load_dwordx2 v[28:29], v7, s[16:19], s26 offen offset:1024
  s_add_u32 s26, s26, 81920
  buffer_load_dwordx2 v[16:17], v241, s[16:19], s26 offen
  buffer_load_dwordx2 v[18:19], v241, s[16:19], s26 offen offset:512
  buffer_load_dwordx2 v[32:33], v7, s[16:19], s26 offen offset:1024
  s_add_u32 s26, s26, 81920
  buffer_load_dwordx2 v[20:21], v241, s[16:19], s26 offen
  buffer_load_dwordx2 v[22:23], v241, s[16:19], s26 offen offset:512
  buffer_load_dwordx2 v[36:37], v7, s[16:19], s26 offen offset:1024
  s_lshl_b32 s27, s25, 7
  s_add_u32 s27, s27, 2854912
  buffer_load_dword v240, v4, s[16:19], s27 offen
  buffer_load_dwordx4 v[40:43], v2, s[16:19], s30 offen
  buffer_load_dwordx2 v[44:45], v241, s[16:19], s30 offen offset:3072
  buffer_load_dwordx4 v[48:51], v2, s[16:19], s30 offen offset:1024
  buffer_load_dwordx4 v[52:55], v2, s[16:19], s30 offen offset:2048
  s_add_u32 s30, s30, 3584
  s_barrier
  v_mov_b32 v46, 0x3f803f80
  v_mov_b32 v47, 0x00003f80
  v_mov_b32 v62, 0x3f803f80
  v_mov_b32 v63, 0x00003f80
  v_mov_b32 v78, 0x3f803f80
  v_mov_b32 v79, 0x00003f80
  v_mov_b32 v94, 0x3f803f80
  v_mov_b32 v95, 0x00003f80
  v_mov_b32 v96, 0
  v_mov_b32 v97, 0
  v_mov_b32 v98, 0
  v_mov_b32 v99, 0
  v_mov_b32 v100, 0
  v_mov_b32 v101, 0
  v_mov_b32 v102, 0
  v_mov_b32 v103, 0
  v_mov_b32 v120, 0
  v_mov_b32 v121, 0
  v_mov_b32 v122, 0
  v_mov_b32 v123, 0
  v_mov_b32 v124, 0
  v_mov_b32 v125, 0
  v_mov_b32 v126, 0
  v_mov_b32 v127, 0
  v_mov_b32 v128, 0
  v_mov_b32 v129, 0
  v_mov_b32 v130, 0
  v_mov_b32 v131, 0
  v_mov_b32 v132, 0
  v_mov_b32 v133, 0
  v_mov_b32 v134, 0
  v_mov_b32 v135, 0
  v_mov_b32 v144, 0
  v_mov_b32 v145, 0
  v_mov_b32 v146, 0
  v_mov_b32 v147, 0
  v_mov_b32 v148, 0
  v_mov_b32 v149, 0
  v_mov_b32 v150, 0
  v_mov_b32 v151, 0
  v_mov_b32 v136, 0
  v_mov_b32 v137, 0
  v_mov_b32 v138, 0
  v_mov_b32 v139, 0
  v_mov_b32 v140, 0
  v_mov_b32 v141, 0
  v_mov_b32 v142, 0
  v_mov_b32 v143, 0
  v_mov_b32 v152, 0
  v_mov_b32 v153, 0
  v_mov_b32 v154, 0
  v_mov_b32 v155, 0
  v_mov_b32 v156, 0
  v_mov_b32 v157, 0
  v_mov_b32 v158, 0
  v_mov_b32 v159, 0
  v_mov_b32 v160, 0
  v_mov_b32 v161, 0
  v_mov_b32 v162, 0
  v_mov_b32 v163, 0
  v_mov_b32 v164, 0
  v_mov_b32 v165, 0
  v_mov_b32 v166, 0
  v_mov_b32 v167, 0
  v_mov_b32 v168, 0
  v_mov_b32 v169, 0
  v_mov_b32 v170, 0
  v_mov_b32 v171, 0
  v_mov_b32 v172, 0
  v_mov_b32 v173, 0
  v_mov_b32 v174, 0
  v_mov_b32 v175, 0
  v_mov_b32 v176, 0
  v_mov_b32 v177, 0
  v_mov_b32 v178, 0
  v_mov_b32 v179, 0
  v_mov_b32 v180, 0
  v_mov_b32 v181, 0
  v_mov_b32 v182, 0
  v_mov_b32 v183, 0
  v_mov_b32 v184, 0
  v_mov_b32 v185, 0
  v_mov_b32 v186, 0
  v_mov_b32 v187, 0
  v_mov_b32 v188, 0
  v_mov_b32 v189, 0
  v_mov_b32 v190, 0
  v_mov_b32 v191, 0
  v_mov_b32 v192, 0
  v_mov_b32 v193, 0
  v_mov_b32 v194, 0
  v_mov_b32 v195, 0
  v_mov_b32 v196, 0
  v_mov_b32 v197, 0
  v_mov_b32 v198, 0
  v_mov_b32 v199, 0
  v_mov_b32 v200, 0
  v_mov_b32 v201, 0
  v_mov_b32 v202, 0
  v_mov_b32 v203, 0
  v_mov_b32 v204, 0
  v_mov_b32 v205, 0
  v_mov_b32 v206, 0
  v_mov_b32 v207, 0
  v_mov_b32 v208, 0
  v_mov_b32 v209, 0
  v_mov_b32 v210, 0
  v_mov_b32 v211, 0
  v_mov_b32 v212, 0
  v_mov_b32 v213, 0
  v_mov_b32 v214, 0
  v_mov_b32 v215, 0
  s_waitcnt vmcnt(17)
  v_max_f32_dpp v216, v216, v216 row_shr:1
  s_nop 1
  v_max_f32_dpp v216, v216, v216 row_shr:2
  s_nop 1
  v_max_f32_dpp v216, v216, v216 row_shr:4
  s_nop 1
  v_max_f32_dpp v216, v216, v216 row_shr:8
  s_nop 1
  v_max_f32_dpp v216, v216, v216 row_bcast:15 row_mask:0xa
  s_nop 1
  v_max_f32_dpp v216, v216, v216 row_bcast:31 row_mask:0xc
  s_nop 1
  v_readlane_b32 s36, v216, 63
  s_nop 2
  s_waitcnt vmcnt(4)
  v_dot2_f32_bf16 v220, v8, v8, 0
  v_dot2_f32_bf16 v221, v12, v12, 0
  v_dot2_f32_bf16 v222, v16, v16, 0
  v_dot2_f32_bf16 v223, v20, v20, 0
  v_dot2_f32_bf16 v220, v9, v9, v220
  buffer_load_dwordx4 v[56:59], v2, s[16:19], s30 offen
  v_dot2_f32_bf16 v221, v13, v13, v221
  v_dot2_f32_bf16 v222, v17, v17, v222
  v_dot2_f32_bf16 v223, v21, v21, v223
  v_dot2_f32_bf16 v220, v10, v10, v220
  v_dot2_f32_bf16 v221, v14, v14, v221
  buffer_load_dwordx2 v[60:61], v241, s[16:19], s30 offen offset:3072
  v_dot2_f32_bf16 v222, v18, v18, v222
  v_dot2_f32_bf16 v223, v22, v22, v223
  v_dot2_f32_bf16 v220, v11, v11, v220
  v_dot2_f32_bf16 v221, v15, v15, v221
  v_dot2_f32_bf16 v222, v19, v19, v222
  buffer_load_dwordx4 v[64:67], v2, s[16:19], s30 offen offset:1024
  v_dot2_f32_bf16 v223, v23, v23, v223
  v_dot2_f32_bf16 v220, v24, v24, v220
  v_dot2_f32_bf16 v221, v28, v28, v221
  v_dot2_f32_bf16 v222, v32, v32, v222
  v_dot2_f32_bf16 v223, v36, v36, v223
  buffer_load_dwordx4 v[68:71], v2, s[16:19], s30 offen offset:2048
  s_add_u32 s30, s30, 3584
  v_dot2_f32_bf16 v220, v25, v25, v220
  v_dot2_f32_bf16 v221, v29, v29, v221
  v_dot2_f32_bf16 v222, v33, v33, v222
  v_dot2_f32_bf16 v223, v37, v37, v223
  v_mov_b32 v224, v220
  buffer_load_dwordx4 v[72:75], v2, s[16:19], s30 offen
  v_mov_b32 v225, v221
  v_mov_b32 v226, v222
  v_mov_b32 v227, v223
  s_nop 1
  v_permlane32_swap_b32 v220, v224
  buffer_load_dwordx2 v[76:77], v241, s[16:19], s30 offen offset:3072
  v_permlane32_swap_b32 v221, v225
  v_permlane32_swap_b32 v222, v226
  v_permlane32_swap_b32 v223, v227
  s_nop 0
  v_add_f32 v220, v220, v224
  buffer_load_dwordx4 v[80:83], v2, s[16:19], s30 offen offset:1024
  v_add_f32 v221, v221, v225
  v_add_f32 v222, v222, v226
  v_add_f32 v223, v223, v227
  v_mov_b32 v218, 1065604874
  v_mul_f32 v218, s36, v218
  buffer_load_dwordx4 v[84:87], v2, s[16:19], s30 offen offset:2048
  s_add_u32 s30, s30, 3584
  v_mul_f32 v220, v218, v220
  v_mul_f32 v221, v218, v221
  v_mul_f32 v222, v218, v222
  v_mul_f32 v223, v218, v223
  v_sqrt_f32 v220, v220
  v_sqrt_f32 v221, v221
  v_sqrt_f32 v222, v222
  v_sqrt_f32 v223, v223
  s_nop 0
  v_max_f32 v218, v220, v221
  v_max3_f32 v218, v218, v222, v223
  v_mov_b32 v219, 1109393408
  v_cmp_nle_f32 vcc, v218, v219
  s_nop 1
  s_cmp_lg_u64 vcc, 0
  s_cbranch_scc0 kd_kernel_mok
  v_mov_b32 v26, 0
  v_mov_b32 v27, 0
  v_mov_b32 v220, 0xff800000
  v_mov_b32 v30, 0
  v_mov_b32 v31, 0
  v_mov_b32 v221, 0xff800000
  v_mov_b32 v34, 0
  v_mov_b32 v35, 0
  v_mov_b32 v222, 0xff800000
  v_mov_b32 v38, 0
  v_mov_b32 v39, 0
  v_mov_b32 v223, 0xff800000
  s_mov_b32 s32, 2621440
  s_mov_b32 s33, 64
kd_kernel_fb_loop:
  buffer_load_dwordx4 v[88:91], v2, s[16:19], s32 offen
  buffer_load_dwordx2 v[92:93], v241, s[16:19], s32 offen offset:3072
  s_waitcnt vmcnt(0)
  v_mfma_f32_32x32x16_bf16 v[104:119], v[88:91], v[8:11], 0
  s_nop 15
  v_mfma_f32_32x32x8bf16_1k v[104:119], v[92:93], v[24:25], v[104:119]
  s_nop 15
  v_max3_f32 v220, v220, v104, v105
  v_max3_f32 v220, v220, v106, v107
  v_max3_f32 v220, v220, v108, v109
  v_max3_f32 v220, v220, v110, v111
  v_max3_f32 v220, v220, v112, v113
  v_max3_f32 v220, v220, v114, v115
  v_max3_f32 v220, v220, v116, v117
  v_max3_f32 v220, v220, v118, v119
  v_mfma_f32_32x32x16_bf16 v[104:119], v[88:91], v[12:15], 0
  s_nop 15
  v_mfma_f32_32x32x8bf16_1k v[104:119], v[92:93], v[28:29], v[104:119]
  s_nop 15
  v_max3_f32 v221, v221, v104, v105
  v_max3_f32 v221, v221, v106, v107
  v_max3_f32 v221, v221, v108, v109
  v_max3_f32 v221, v221, v110, v111
  v_max3_f32 v221, v221, v112, v113
  v_max3_f32 v221, v221, v114, v115
  v_max3_f32 v221, v221, v116, v117
  v_max3_f32 v221, v221, v118, v119
  v_mfma_f32_32x32x16_bf16 v[104:119], v[88:91], v[16:19], 0
  s_nop 15
  v_mfma_f32_32x32x8bf16_1k v[104:119], v[92:93], v[32:33], v[104:119]
  s_nop 15
  v_max3_f32 v222, v222, v104, v105
  v_max3_f32 v222, v222, v106, v107
  v_max3_f32 v222, v222, v108, v109
  v_max3_f32 v222, v222, v110, v111
  v_max3_f32 v222, v222, v112, v113
  v_max3_f32 v222, v222, v114, v115
  v_max3_f32 v222, v222, v116, v117
  v_max3_f32 v222, v222, v118, v119
  v_mfma_f32_32x32x16_bf16 v[104:119], v[88:91], v[20:23], 0
  s_nop 15
  v_mfma_f32_32x32x8bf16_1k v[104:119], v[92:93], v[36:37], v[104:119]
  s_nop 15
  v_max3_f32 v223, v223, v104, v105
  v_max3_f32 v223, v223, v106, v107
  v_max3_f32 v223, v223, v108, v109
  v_max3_f32 v223, v223, v110, v111
  v_max3_f32 v223, v223, v112, v113
  v_max3_f32 v223, v223, v114, v115
  v_max3_f32 v223, v223, v116, v117
  v_max3_f32 v223, v223, v118, v119
  s_add_u32 s32, s32, 3584
  s_sub_u32 s33, s33, 1
  s_cmp_lg_u32 s33, 0
  s_cbranch_scc1 kd_kernel_fb_loop
  v_mov_b32 v218, v220
  s_nop 1
  v_permlane32_swap_b32 v220, v218
  s_nop 1
  v_max_f32 v220, v220, v218
  v_mov_b32 v218, v221
  s_nop 1
  v_permlane32_swap_b32 v221, v218
  s_nop 1
  v_max_f32 v221, v221, v218
  v_mov_b32 v218, v222
  s_nop 1
  v_permlane32_swap_b32 v222, v218
  s_nop 1
  v_max_f32 v222, v222, v218
  v_mov_b32 v218, v223
  s_nop 1
  v_permlane32_swap_b32 v223, v218
  s_nop 1
  v_max_f32 v223, v223, v218
kd_kernel_mok:
  v_mul_f32 v240, 3216550459, v240
  v_exp_f32 v240, v240
  s_nop 0
  v_add_f32 v240, 1.0, v240
  v_rcp_f32 v240, v240
  v_cmp_gt_u32 vcc, 32, v1
  v_sub_f32 v220, 0, v220
  v_and_b32 v218, 0xffff0000, v220
  v_sub_f32 v220, v220, v218
  v_and_b32 v219, 0xffff0000, v220
  v_sub_f32 v220, v220, v219
  v_lshrrev_b32 v218, 16, v218
  v_or_b32 v218, v218, v219
  v_lshrrev_b32 v220, 16, v220
  v_cndmask_b32 v24, v218, v24, vcc
  v_cndmask_b32 v25, v220, v25, vcc
  v_sub_f32 v221, 0, v221
  v_and_b32 v218, 0xffff0000, v221
  v_sub_f32 v221, v221, v218
  v_and_b32 v219, 0xffff0000, v221
  v_sub_f32 v221, v221, v219
  v_lshrrev_b32 v218, 16, v218
  v_or_b32 v218, v218, v219
  v_lshrrev_b32 v221, 16, v221
  v_cndmask_b32 v28, v218, v28, vcc
  v_cndmask_b32 v29, v221, v29, vcc
  v_sub_f32 v222, 0, v222
  v_and_b32 v218, 0xffff0000, v222
  v_sub_f32 v222, v222, v218
  v_and_b32 v219, 0xffff0000, v222
  v_sub_f32 v222, v222, v219
  v_lshrrev_b32 v218, 16, v218
  v_or_b32 v218, v218, v219
  v_lshrrev_b32 v222, 16, v222
  v_cndmask_b32 v32, v218, v32, vcc
  v_cndmask_b32 v33, v222, v33, vcc
  v_sub_f32 v223, 0, v223
  v_and_b32 v218, 0xffff0000, v223
  v_sub_f32 v223, v223, v218
  v_and_b32 v219, 0xffff0000, v223
  v_sub_f32 v223, v223, v219
  v_lshrrev_b32 v218, 16, v218
  v_or_b32 v218, v218, v219
  v_lshrrev_b32 v223, 16, v223
  v_cndmask_b32 v36, v218, v36, vcc
  v_cndmask_b32 v37, v223, v37, vcc
  s_mov_b32 s33, 8
kd_kernel_loop:
  s_waitcnt vmcnt(8)
  v_mfma_f32_32x32x16_bf16 v[104:119], v[40:43], v[8:11], 0
  v_exp_f32 v136, v120
  v_exp_f32 v137, v121
  v_exp_f32 v138, v122
  v_exp_f32 v139, v123
  v_cvt_pk_bf16_f32 v144, v136, v137
  v_cvt_pk_bf16_f32 v145, v138, v139
  v_mfma_f32_32x32x16_bf16 v[184:199], v[100:103], v[148:151], v[184:199]
  v_exp_f32 v140, v124
  v_exp_f32 v141, v125
  v_exp_f32 v142, v126
  v_exp_f32 v143, v127
  v_cvt_pk_bf16_f32 v146, v140, v141
  v_cvt_pk_bf16_f32 v147, v142, v143
  v_mfma_f32_32x32x8bf16_1k v[104:119], v[44:45], v[24:25], v[104:119]
  v_exp_f32 v136, v128
  v_exp_f32 v137, v129
  v_exp_f32 v138, v130
  v_exp_f32 v139, v131
  v_cvt_pk_bf16_f32 v148, v136, v137
  v_cvt_pk_bf16_f32 v149, v138, v139
  v_mfma_f32_32x32x16_bf16 v[200:215], v[96:99], v[144:147], v[200:215]
  v_exp_f32 v140, v132
  v_exp_f32 v141, v133
  v_exp_f32 v142, v134
  v_exp_f32 v143, v135
  v_cvt_pk_bf16_f32 v150, v140, v141
  v_cvt_pk_bf16_f32 v151, v142, v143
  v_mfma_f32_32x32x16_bf16 v[120:135], v[40:43], v[12:15], 0
  v_exp_f32 v136, v104
  v_exp_f32 v137, v105
  v_exp_f32 v138, v106
  v_exp_f32 v139, v107
  v_cvt_pk_bf16_f32 v144, v136, v137
  v_cvt_pk_bf16_f32 v145, v138, v139
  v_mfma_f32_32x32x16_bf16 v[200:215], v[100:103], v[148:151], v[200:215]
  v_exp_f32 v140, v108
  v_exp_f32 v141, v109
  v_exp_f32 v142, v110
  v_exp_f32 v143, v111
  v_cvt_pk_bf16_f32 v146, v140, v141
  v_cvt_pk_bf16_f32 v147, v142, v143
  v_mfma_f32_32x32x8bf16_1k v[120:135], v[44:45], v[28:29], v[120:135]
  v_exp_f32 v136, v112
  v_exp_f32 v137, v113
  v_exp_f32 v138, v114
  v_exp_f32 v139, v115
  v_cvt_pk_bf16_f32 v148, v136, v137
  v_cvt_pk_bf16_f32 v149, v138, v139
  v_mfma_f32_32x32x16_bf16 v[152:167], v[48:51], v[144:147], v[152:167]
  v_exp_f32 v140, v116
  v_exp_f32 v141, v117
  v_exp_f32 v142, v118
  v_exp_f32 v143, v119
  v_cvt_pk_bf16_f32 v150, v140, v141
  v_cvt_pk_bf16_f32 v151, v142, v143
  v_mfma_f32_32x32x16_bf16 v[104:119], v[40:43], v[16:19], 0
  v_exp_f32 v136, v120
  v_exp_f32 v137, v121
  v_exp_f32 v138, v122
  v_exp_f32 v139, v123
  v_cvt_pk_bf16_f32 v144, v136, v137
  v_cvt_pk_bf16_f32 v145, v138, v139
  buffer_load_dwordx4 v[88:91], v2, s[16:19], s30 offen
  v_mfma_f32_32x32x16_bf16 v[152:167], v[52:55], v[148:151], v[152:167]
  v_exp_f32 v140, v124
  v_exp_f32 v141, v125
  v_exp_f32 v142, v126
  v_exp_f32 v143, v127
  v_cvt_pk_bf16_f32 v146, v140, v141
  v_cvt_pk_bf16_f32 v147, v142, v143
  buffer_load_dwordx2 v[92:93], v241, s[16:19], s30 offen offset:3072
  v_mfma_f32_32x32x8bf16_1k v[104:119], v[44:45], v[32:33], v[104:119]
  v_exp_f32 v136, v128
  v_exp_f32 v137, v129
  v_exp_f32 v138, v130
  v_exp_f32 v139, v131
  v_cvt_pk_bf16_f32 v148, v136, v137
  v_cvt_pk_bf16_f32 v149, v138, v139
  buffer_load_dwordx4 v[96:99], v2, s[16:19], s30 offen offset:1024
  v_mfma_f32_32x32x16_bf16 v[168:183], v[48:51], v[144:147], v[168:183]
  v_exp_f32 v140, v132
  v_exp_f32 v141, v133
  v_exp_f32 v142, v134
  v_exp_f32 v143, v135
  v_cvt_pk_bf16_f32 v150, v140, v141
  v_cvt_pk_bf16_f32 v151, v142, v143
  buffer_load_dwordx4 v[100:103], v2, s[16:19], s30 offen offset:2048
  s_add_u32 s30, s30, 3584
  v_mfma_f32_32x32x16_bf16 v[120:135], v[40:43], v[20:23], 0
  v_exp_f32 v136, v104
  v_exp_f32 v137, v105
  v_exp_f32 v138, v106
  v_exp_f32 v139, v107
  v_cvt_pk_bf16_f32 v144, v136, v137
  v_cvt_pk_bf16_f32 v145, v138, v139
  v_mfma_f32_32x32x16_bf16 v[168:183], v[52:55], v[148:151], v[168:183]
  v_exp_f32 v140, v108
  v_exp_f32 v141, v109
  v_exp_f32 v142, v110
  v_exp_f32 v143, v111
  v_cvt_pk_bf16_f32 v146, v140, v141
  v_cvt_pk_bf16_f32 v147, v142, v143
  v_mfma_f32_32x32x8bf16_1k v[120:135], v[44:45], v[36:37], v[120:135]
  v_exp_f32 v136, v112
  v_exp_f32 v137, v113
  v_exp_f32 v138, v114
  v_exp_f32 v139, v115
  v_cvt_pk_bf16_f32 v148, v136, v137
  v_cvt_pk_bf16_f32 v149, v138, v139
  v_mfma_f32_32x32x16_bf16 v[184:199], v[48:51], v[144:147], v[184:199]
  v_exp_f32 v140, v116
  v_exp_f32 v141, v117
  v_exp_f32 v142, v118
  v_exp_f32 v143, v119
  v_cvt_pk_bf16_f32 v150, v140, v141
  v_cvt_pk_bf16_f32 v151, v142, v143
  s_waitcnt vmcnt(8)
  v_mfma_f32_32x32x16_bf16 v[104:119], v[56:59], v[8:11], 0
  v_exp_f32 v136, v120
  v_exp_f32 v137, v121
  v_exp_f32 v138, v122
  v_exp_f32 v139, v123
  v_cvt_pk_bf16_f32 v144, v136, v137
  v_cvt_pk_bf16_f32 v145, v138, v139
  v_mfma_f32_32x32x16_bf16 v[184:199], v[52:55], v[148:151], v[184:199]
  v_exp_f32 v140, v124
  v_exp_f32 v141, v125
  v_exp_f32 v142, v126
  v_exp_f32 v143, v127
  v_cvt_pk_bf16_f32 v146, v140, v141
  v_cvt_pk_bf16_f32 v147, v142, v143
  v_mfma_f32_32x32x8bf16_1k v[104:119], v[60:61], v[24:25], v[104:119]
  v_exp_f32 v136, v128
  v_exp_f32 v137, v129
  v_exp_f32 v138, v130
  v_exp_f32 v139, v131
  v_cvt_pk_bf16_f32 v148, v136, v137
  v_cvt_pk_bf16_f32 v149, v138, v139
  v_mfma_f32_32x32x16_bf16 v[200:215], v[48:51], v[144:147], v[200:215]
  v_exp_f32 v140, v132
  v_exp_f32 v141, v133
  v_exp_f32 v142, v134
  v_exp_f32 v143, v135
  v_cvt_pk_bf16_f32 v150, v140, v141
  v_cvt_pk_bf16_f32 v151, v142, v143
  v_mfma_f32_32x32x16_bf16 v[120:135], v[56:59], v[12:15], 0
  v_exp_f32 v136, v104
  v_exp_f32 v137, v105
  v_exp_f32 v138, v106
  v_exp_f32 v139, v107
  v_cvt_pk_bf16_f32 v144, v136, v137
  v_cvt_pk_bf16_f32 v145, v138, v139
  v_mfma_f32_32x32x16_bf16 v[200:215], v[52:55], v[148:151], v[200:215]
  v_exp_f32 v140, v108
  v_exp_f32 v141, v109
  v_exp_f32 v142, v110
  v_exp_f32 v143, v111
  v_cvt_pk_bf16_f32 v146, v140, v141
  v_cvt_pk_bf16_f32 v147, v142, v143
  v_mfma_f32_32x32x8bf16_1k v[120:135], v[60:61], v[28:29], v[120:135]
  v_exp_f32 v136, v112
  v_exp_f32 v137, v113
  v_exp_f32 v138, v114
  v_exp_f32 v139, v115
  v_cvt_pk_bf16_f32 v148, v136, v137
  v_cvt_pk_bf16_f32 v149, v138, v139
  v_mfma_f32_32x32x16_bf16 v[152:167], v[64:67], v[144:147], v[152:167]
  v_exp_f32 v140, v116
  v_exp_f32 v141, v117
  v_exp_f32 v142, v118
  v_exp_f32 v143, v119
  v_cvt_pk_bf16_f32 v150, v140, v141
  v_cvt_pk_bf16_f32 v151, v142, v143
  v_mfma_f32_32x32x16_bf16 v[104:119], v[56:59], v[16:19], 0
  v_exp_f32 v136, v120
  v_exp_f32 v137, v121
  v_exp_f32 v138, v122
  v_exp_f32 v139, v123
  v_cvt_pk_bf16_f32 v144, v136, v137
  v_cvt_pk_bf16_f32 v145, v138, v139
  buffer_load_dwordx4 v[40:43], v2, s[16:19], s30 offen
  v_mfma_f32_32x32x16_bf16 v[152:167], v[68:71], v[148:151], v[152:167]
  v_exp_f32 v140, v124
  v_exp_f32 v141, v125
  v_exp_f32 v142, v126
  v_exp_f32 v143, v127
  v_cvt_pk_bf16_f32 v146, v140, v141
  v_cvt_pk_bf16_f32 v147, v142, v143
  buffer_load_dwordx2 v[44:45], v241, s[16:19], s30 offen offset:3072
  v_mfma_f32_32x32x8bf16_1k v[104:119], v[60:61], v[32:33], v[104:119]
  v_exp_f32 v136, v128
  v_exp_f32 v137, v129
  v_exp_f32 v138, v130
  v_exp_f32 v139, v131
  v_cvt_pk_bf16_f32 v148, v136, v137
  v_cvt_pk_bf16_f32 v149, v138, v139
  buffer_load_dwordx4 v[48:51], v2, s[16:19], s30 offen offset:1024
  v_mfma_f32_32x32x16_bf16 v[168:183], v[64:67], v[144:147], v[168:183]
  v_exp_f32 v140, v132
  v_exp_f32 v141, v133
  v_exp_f32 v142, v134
  v_exp_f32 v143, v135
  v_cvt_pk_bf16_f32 v150, v140, v141
  v_cvt_pk_bf16_f32 v151, v142, v143
  buffer_load_dwordx4 v[52:55], v2, s[16:19], s30 offen offset:2048
  s_add_u32 s30, s30, 3584
  v_mfma_f32_32x32x16_bf16 v[120:135], v[56:59], v[20:23], 0
  v_exp_f32 v136, v104
  v_exp_f32 v137, v105
  v_exp_f32 v138, v106
  v_exp_f32 v139, v107
  v_cvt_pk_bf16_f32 v144, v136, v137
  v_cvt_pk_bf16_f32 v145, v138, v139
  v_mfma_f32_32x32x16_bf16 v[168:183], v[68:71], v[148:151], v[168:183]
  v_exp_f32 v140, v108
  v_exp_f32 v141, v109
  v_exp_f32 v142, v110
  v_exp_f32 v143, v111
  v_cvt_pk_bf16_f32 v146, v140, v141
  v_cvt_pk_bf16_f32 v147, v142, v143
  v_mfma_f32_32x32x8bf16_1k v[120:135], v[60:61], v[36:37], v[120:135]
  v_exp_f32 v136, v112
  v_exp_f32 v137, v113
  v_exp_f32 v138, v114
  v_exp_f32 v139, v115
  v_cvt_pk_bf16_f32 v148, v136, v137
  v_cvt_pk_bf16_f32 v149, v138, v139
  v_mfma_f32_32x32x16_bf16 v[184:199], v[64:67], v[144:147], v[184:199]
  v_exp_f32 v140, v116
  v_exp_f32 v141, v117
  v_exp_f32 v142, v118
  v_exp_f32 v143, v119
  v_cvt_pk_bf16_f32 v150, v140, v141
  v_cvt_pk_bf16_f32 v151, v142, v143
  s_waitcnt vmcnt(8)
  v_mfma_f32_32x32x16_bf16 v[104:119], v[72:75], v[8:11], 0
  v_exp_f32 v136, v120
  v_exp_f32 v137, v121
  v_exp_f32 v138, v122
  v_exp_f32 v139, v123
  v_cvt_pk_bf16_f32 v144, v136, v137
  v_cvt_pk_bf16_f32 v145, v138, v139
  v_mfma_f32_32x32x16_bf16 v[184:199], v[68:71], v[148:151], v[184:199]
  v_exp_f32 v140, v124
  v_exp_f32 v141, v125
  v_exp_f32 v142, v126
  v_exp_f32 v143, v127
  v_cvt_pk_bf16_f32 v146, v140, v141
  v_cvt_pk_bf16_f32 v147, v142, v143
  v_mfma_f32_32x32x8bf16_1k v[104:119], v[76:77], v[24:25], v[104:119]
  v_exp_f32 v136, v128
  v_exp_f32 v137, v129
  v_exp_f32 v138, v130
  v_exp_f32 v139, v131
  v_cvt_pk_bf16_f32 v148, v136, v137
  v_cvt_pk_bf16_f32 v149, v138, v139
  v_mfma_f32_32x32x16_bf16 v[200:215], v[64:67], v[144:147], v[200:215]
  v_exp_f32 v140, v132
  v_exp_f32 v141, v133
  v_exp_f32 v142, v134
  v_exp_f32 v143, v135
  v_cvt_pk_bf16_f32 v150, v140, v141
  v_cvt_pk_bf16_f32 v151, v142, v143
  v_mfma_f32_32x32x16_bf16 v[120:135], v[72:75], v[12:15], 0
  v_exp_f32 v136, v104
  v_exp_f32 v137, v105
  v_exp_f32 v138, v106
  v_exp_f32 v139, v107
  v_cvt_pk_bf16_f32 v144, v136, v137
  v_cvt_pk_bf16_f32 v145, v138, v139
  v_mfma_f32_32x32x16_bf16 v[200:215], v[68:71], v[148:151], v[200:215]
  v_exp_f32 v140, v108
  v_exp_f32 v141, v109
  v_exp_f32 v142, v110
  v_exp_f32 v143, v111
  v_cvt_pk_bf16_f32 v146, v140, v141
  v_cvt_pk_bf16_f32 v147, v142, v143
  v_mfma_f32_32x32x8bf16_1k v[120:135], v[76:77], v[28:29], v[120:135]
  v_exp_f32 v136, v112
  v_exp_f32 v137, v113
  v_exp_f32 v138, v114
  v_exp_f32 v139, v115
  v_cvt_pk_bf16_f32 v148, v136, v137
  v_cvt_pk_bf16_f32 v149, v138, v139
  v_mfma_f32_32x32x16_bf16 v[152:167], v[80:83], v[144:147], v[152:167]
  v_exp_f32 v140, v116
  v_exp_f32 v141, v117
  v_exp_f32 v142, v118
  v_exp_f32 v143, v119
  v_cvt_pk_bf16_f32 v150, v140, v141
  v_cvt_pk_bf16_f32 v151, v142, v143
  v_mfma_f32_32x32x16_bf16 v[104:119], v[72:75], v[16:19], 0
  v_exp_f32 v136, v120
  v_exp_f32 v137, v121
  v_exp_f32 v138, v122
  v_exp_f32 v139, v123
  v_cvt_pk_bf16_f32 v144, v136, v137
  v_cvt_pk_bf16_f32 v145, v138, v139
  buffer_load_dwordx4 v[56:59], v2, s[16:19], s30 offen
  v_mfma_f32_32x32x16_bf16 v[152:167], v[84:87], v[148:151], v[152:167]
  v_exp_f32 v140, v124
  v_exp_f32 v141, v125
  v_exp_f32 v142, v126
  v_exp_f32 v143, v127
  v_cvt_pk_bf16_f32 v146, v140, v141
  v_cvt_pk_bf16_f32 v147, v142, v143
  buffer_load_dwordx2 v[60:61], v241, s[16:19], s30 offen offset:3072
  v_mfma_f32_32x32x8bf16_1k v[104:119], v[76:77], v[32:33], v[104:119]
  v_exp_f32 v136, v128
  v_exp_f32 v137, v129
  v_exp_f32 v138, v130
  v_exp_f32 v139, v131
  v_cvt_pk_bf16_f32 v148, v136, v137
  v_cvt_pk_bf16_f32 v149, v138, v139
  buffer_load_dwordx4 v[64:67], v2, s[16:19], s30 offen offset:1024
  v_mfma_f32_32x32x16_bf16 v[168:183], v[80:83], v[144:147], v[168:183]
  v_exp_f32 v140, v132
  v_exp_f32 v141, v133
  v_exp_f32 v142, v134
  v_exp_f32 v143, v135
  v_cvt_pk_bf16_f32 v150, v140, v141
  v_cvt_pk_bf16_f32 v151, v142, v143
  buffer_load_dwordx4 v[68:71], v2, s[16:19], s30 offen offset:2048
  s_add_u32 s30, s30, 3584
  v_mfma_f32_32x32x16_bf16 v[120:135], v[72:75], v[20:23], 0
  v_exp_f32 v136, v104
  v_exp_f32 v137, v105
  v_exp_f32 v138, v106
  v_exp_f32 v139, v107
  v_cvt_pk_bf16_f32 v144, v136, v137
  v_cvt_pk_bf16_f32 v145, v138, v139
  v_mfma_f32_32x32x16_bf16 v[168:183], v[84:87], v[148:151], v[168:183]
  v_exp_f32 v140, v108
  v_exp_f32 v141, v109
  v_exp_f32 v142, v110
  v_exp_f32 v143, v111
  v_cvt_pk_bf16_f32 v146, v140, v141
  v_cvt_pk_bf16_f32 v147, v142, v143
  v_mfma_f32_32x32x8bf16_1k v[120:135], v[76:77], v[36:37], v[120:135]
  v_exp_f32 v136, v112
  v_exp_f32 v137, v113
  v_exp_f32 v138, v114
  v_exp_f32 v139, v115
  v_cvt_pk_bf16_f32 v148, v136, v137
  v_cvt_pk_bf16_f32 v149, v138, v139
  v_mfma_f32_32x32x16_bf16 v[184:199], v[80:83], v[144:147], v[184:199]
  v_exp_f32 v140, v116
  v_exp_f32 v141, v117
  v_exp_f32 v142, v118
  v_exp_f32 v143, v119
  v_cvt_pk_bf16_f32 v150, v140, v141
  v_cvt_pk_bf16_f32 v151, v142, v143
  s_waitcnt vmcnt(8)
  v_mfma_f32_32x32x16_bf16 v[104:119], v[88:91], v[8:11], 0
  v_exp_f32 v136, v120
  v_exp_f32 v137, v121
  v_exp_f32 v138, v122
  v_exp_f32 v139, v123
  v_cvt_pk_bf16_f32 v144, v136, v137
  v_cvt_pk_bf16_f32 v145, v138, v139
  v_mfma_f32_32x32x16_bf16 v[184:199], v[84:87], v[148:151], v[184:199]
  v_exp_f32 v140, v124
  v_exp_f32 v141, v125
  v_exp_f32 v142, v126
  v_exp_f32 v143, v127
  v_cvt_pk_bf16_f32 v146, v140, v141
  v_cvt_pk_bf16_f32 v147, v142, v143
  v_mfma_f32_32x32x8bf16_1k v[104:119], v[92:93], v[24:25], v[104:119]
  v_exp_f32 v136, v128
  v_exp_f32 v137, v129
  v_exp_f32 v138, v130
  v_exp_f32 v139, v131
  v_cvt_pk_bf16_f32 v148, v136, v137
  v_cvt_pk_bf16_f32 v149, v138, v139
  v_mfma_f32_32x32x16_bf16 v[200:215], v[80:83], v[144:147], v[200:215]
  v_exp_f32 v140, v132
  v_exp_f32 v141, v133
  v_exp_f32 v142, v134
  v_exp_f32 v143, v135
  v_cvt_pk_bf16_f32 v150, v140, v141
  v_cvt_pk_bf16_f32 v151, v142, v143
  v_mfma_f32_32x32x16_bf16 v[120:135], v[88:91], v[12:15], 0
  v_exp_f32 v136, v104
  v_exp_f32 v137, v105
  v_exp_f32 v138, v106
  v_exp_f32 v139, v107
  v_cvt_pk_bf16_f32 v144, v136, v137
  v_cvt_pk_bf16_f32 v145, v138, v139
  v_mfma_f32_32x32x16_bf16 v[200:215], v[84:87], v[148:151], v[200:215]
  v_exp_f32 v140, v108
  v_exp_f32 v141, v109
  v_exp_f32 v142, v110
  v_exp_f32 v143, v111
  v_cvt_pk_bf16_f32 v146, v140, v141
  v_cvt_pk_bf16_f32 v147, v142, v143
  v_mfma_f32_32x32x8bf16_1k v[120:135], v[92:93], v[28:29], v[120:135]
  v_exp_f32 v136, v112
  v_exp_f32 v137, v113
  v_exp_f32 v138, v114
  v_exp_f32 v139, v115
  v_cvt_pk_bf16_f32 v148, v136, v137
  v_cvt_pk_bf16_f32 v149, v138, v139
  v_mfma_f32_32x32x16_bf16 v[152:167], v[96:99], v[144:147], v[152:167]
  v_exp_f32 v140, v116
  v_exp_f32 v141, v117
  v_exp_f32 v142, v118
  v_exp_f32 v143, v119
  v_cvt_pk_bf16_f32 v150, v140, v141
  v_cvt_pk_bf16_f32 v151, v142, v143
  v_mfma_f32_32x32x16_bf16 v[104:119], v[88:91], v[16:19], 0
  v_exp_f32 v136, v120
  v_exp_f32 v137, v121
  v_exp_f32 v138, v122
  v_exp_f32 v139, v123
  v_cvt_pk_bf16_f32 v144, v136, v137
  v_cvt_pk_bf16_f32 v145, v138, v139
  buffer_load_dwordx4 v[72:75], v2, s[16:19], s30 offen
  v_mfma_f32_32x32x16_bf16 v[152:167], v[100:103], v[148:151], v[152:167]
  v_exp_f32 v140, v124
  v_exp_f32 v141, v125
  v_exp_f32 v142, v126
  v_exp_f32 v143, v127
  v_cvt_pk_bf16_f32 v146, v140, v141
  v_cvt_pk_bf16_f32 v147, v142, v143
  buffer_load_dwordx2 v[76:77], v241, s[16:19], s30 offen offset:3072
  v_mfma_f32_32x32x8bf16_1k v[104:119], v[92:93], v[32:33], v[104:119]
  v_exp_f32 v136, v128
  v_exp_f32 v137, v129
  v_exp_f32 v138, v130
  v_exp_f32 v139, v131
  v_cvt_pk_bf16_f32 v148, v136, v137
  v_cvt_pk_bf16_f32 v149, v138, v139
  buffer_load_dwordx4 v[80:83], v2, s[16:19], s30 offen offset:1024
  v_mfma_f32_32x32x16_bf16 v[168:183], v[96:99], v[144:147], v[168:183]
  v_exp_f32 v140, v132
  v_exp_f32 v141, v133
  v_exp_f32 v142, v134
  v_exp_f32 v143, v135
  v_cvt_pk_bf16_f32 v150, v140, v141
  v_cvt_pk_bf16_f32 v151, v142, v143
  buffer_load_dwordx4 v[84:87], v2, s[16:19], s30 offen offset:2048
  s_add_u32 s30, s30, 3584
  v_mfma_f32_32x32x16_bf16 v[120:135], v[88:91], v[20:23], 0
  v_exp_f32 v136, v104
  v_exp_f32 v137, v105
  v_exp_f32 v138, v106
  v_exp_f32 v139, v107
  v_cvt_pk_bf16_f32 v144, v136, v137
  v_cvt_pk_bf16_f32 v145, v138, v139
  v_mfma_f32_32x32x16_bf16 v[168:183], v[100:103], v[148:151], v[168:183]
  v_exp_f32 v140, v108
  v_exp_f32 v141, v109
  v_exp_f32 v142, v110
  v_exp_f32 v143, v111
  v_cvt_pk_bf16_f32 v146, v140, v141
  v_cvt_pk_bf16_f32 v147, v142, v143
  v_mfma_f32_32x32x8bf16_1k v[120:135], v[92:93], v[36:37], v[120:135]
  v_exp_f32 v136, v112
  v_exp_f32 v137, v113
  v_exp_f32 v138, v114
  v_exp_f32 v139, v115
  v_cvt_pk_bf16_f32 v148, v136, v137
  v_cvt_pk_bf16_f32 v149, v138, v139
  v_mfma_f32_32x32x16_bf16 v[184:199], v[96:99], v[144:147], v[184:199]
  v_exp_f32 v140, v116
  v_exp_f32 v141, v117
  v_exp_f32 v142, v118
  v_exp_f32 v143, v119
  v_cvt_pk_bf16_f32 v150, v140, v141
  v_cvt_pk_bf16_f32 v151, v142, v143
  s_sub_u32 s33, s33, 1
  s_cmp_lg_u32 s33, 0
  s_cbranch_scc1 kd_kernel_loop
  v_exp_f32 v136, v120
  v_exp_f32 v137, v121
  v_exp_f32 v138, v122
  v_exp_f32 v139, v123
  v_cvt_pk_bf16_f32 v144, v136, v137
  v_cvt_pk_bf16_f32 v145, v138, v139
  v_mfma_f32_32x32x16_bf16 v[184:199], v[100:103], v[148:151], v[184:199]
  v_exp_f32 v140, v124
  v_exp_f32 v141, v125
  v_exp_f32 v142, v126
  v_exp_f32 v143, v127
  v_cvt_pk_bf16_f32 v146, v140, v141
  v_cvt_pk_bf16_f32 v147, v142, v143
  v_exp_f32 v136, v128
  v_exp_f32 v137, v129
  v_exp_f32 v138, v130
  v_exp_f32 v139, v131
  v_cvt_pk_bf16_f32 v148, v136, v137
  v_cvt_pk_bf16_f32 v149, v138, v139
  v_mfma_f32_32x32x16_bf16 v[200:215], v[96:99], v[144:147], v[200:215]
  v_exp_f32 v140, v132
  v_exp_f32 v141, v133
  v_exp_f32 v142, v134
  v_exp_f32 v143, v135
  v_cvt_pk_bf16_f32 v150, v140, v141
  v_cvt_pk_bf16_f32 v151, v142, v143
  s_nop 1
  v_mfma_f32_32x32x16_bf16 v[200:215], v[100:103], v[148:151], v[200:215]
  s_mul_i32 s34, s20, 6144
  s_add_u32 s34, s34, 81920
  s_xor_b32 s35, s20, 2
  s_lshl_b32 s39, s35, 2
  s_mul_i32 s35, s35, 6144
  s_add_u32 s35, s35, 81920
  s_nop 7
  v_lshlrev_b32 v13, 2, v1
  v_add_u32 v9, s34, v13
  v_add_u32 v10, s35, v13
  s_cmp_eq_u32 s24, 0
  s_cbranch_scc1 kd_kernel_kh0
  ds_write_b32 v9, v152 offset:0
  ds_write_b32 v9, v153 offset:256
  ds_write_b32 v9, v154 offset:512
  ds_write_b32 v9, v155 offset:768
  ds_write_b32 v9, v156 offset:1024
  ds_write_b32 v9, v157 offset:1280
  ds_write_b32 v9, v158 offset:1536
  ds_write_b32 v9, v159 offset:1792
  ds_write_b32 v9, v160 offset:2048
  ds_write_b32 v9, v161 offset:2304
  ds_write_b32 v9, v162 offset:2560
  ds_write_b32 v9, v163 offset:2816
  ds_write_b32 v9, v168 offset:3072
  ds_write_b32 v9, v169 offset:3328
  ds_write_b32 v9, v170 offset:3584
  ds_write_b32 v9, v171 offset:3840
  ds_write_b32 v9, v172 offset:4096
  ds_write_b32 v9, v173 offset:4352
  ds_write_b32 v9, v174 offset:4608
  ds_write_b32 v9, v175 offset:4864
  ds_write_b32 v9, v176 offset:5120
  ds_write_b32 v9, v177 offset:5376
  ds_write_b32 v9, v178 offset:5632
  ds_write_b32 v9, v179 offset:5888
  v_mov_b32 v152, v184
  v_mov_b32 v153, v185
  v_mov_b32 v154, v186
  v_mov_b32 v155, v187
  v_mov_b32 v156, v188
  v_mov_b32 v157, v189
  v_mov_b32 v158, v190
  v_mov_b32 v159, v191
  v_mov_b32 v160, v192
  v_mov_b32 v161, v193
  v_mov_b32 v162, v194
  v_mov_b32 v163, v195
  v_mov_b32 v168, v200
  v_mov_b32 v169, v201
  v_mov_b32 v170, v202
  v_mov_b32 v171, v203
  v_mov_b32 v172, v204
  v_mov_b32 v173, v205
  v_mov_b32 v174, v206
  v_mov_b32 v175, v207
  v_mov_b32 v176, v208
  v_mov_b32 v177, v209
  v_mov_b32 v178, v210
  v_mov_b32 v179, v211
  s_branch kd_kernel_xch
kd_kernel_kh0:
  ds_write_b32 v9, v184 offset:0
  ds_write_b32 v9, v185 offset:256
  ds_write_b32 v9, v186 offset:512
  ds_write_b32 v9, v187 offset:768
  ds_write_b32 v9, v188 offset:1024
  ds_write_b32 v9, v189 offset:1280
  ds_write_b32 v9, v190 offset:1536
  ds_write_b32 v9, v191 offset:1792
  ds_write_b32 v9, v192 offset:2048
  ds_write_b32 v9, v193 offset:2304
  ds_write_b32 v9, v194 offset:2560
  ds_write_b32 v9, v195 offset:2816
  ds_write_b32 v9, v200 offset:3072
  ds_write_b32 v9, v201 offset:3328
  ds_write_b32 v9, v202 offset:3584
  ds_write_b32 v9, v203 offset:3840
  ds_write_b32 v9, v204 offset:4096
  ds_write_b32 v9, v205 offset:4352
  ds_write_b32 v9, v206 offset:4608
  ds_write_b32 v9, v207 offset:4864
  ds_write_b32 v9, v208 offset:5120
  ds_write_b32 v9, v209 offset:5376
  ds_write_b32 v9, v210 offset:5632
  ds_write_b32 v9, v211 offset:5888
kd_kernel_xch:
  s_lshl_b32 s38, s20, 2
  s_add_u32 s38, s38, 106512
  v_mov_b32 v13, s38
  v_mov_b32 v14, 1
  s_add_u32 s39, s39, 106512
  v_mov_b32 v15, s39
  s_waitcnt lgkmcnt(0)
  ds_write_b32 v13, v14
  v_lshrrev_b32 v11, 4, v5
  s_movk_i32 s36, 20480
  v_mul_lo_u32 v11, v11, s36
  v_and_b32 v12, 15, v5
  v_lshl_add_u32 v11, v12, 4, v11
  v_lshl_add_u32 v12, v6, 8, v11
  s_lshl_b32 s37, s21, 1
  s_add_u32 s37, s37, s24
  s_mul_i32 s37, s37, 1280
  s_mul_i32 s38, s25, 40960
  s_add_u32 s37, s37, s38
  s_add_u32 s37, s37, 9437184
poll_1:
  ds_read_b32 v14, v15 offset:0
  s_waitcnt lgkmcnt(0)
  v_readfirstlane_b32 s36, v14
  s_cmp_lt_u32 s36, 1
  s_cbranch_scc1 poll_1
  ds_read_b32 v184, v10 offset:0
  ds_read_b32 v185, v10 offset:256
  ds_read_b32 v186, v10 offset:512
  ds_read_b32 v187, v10 offset:768
  ds_read_b32 v188, v10 offset:1024
  ds_read_b32 v189, v10 offset:1280
  ds_read_b32 v190, v10 offset:1536
  ds_read_b32 v191, v10 offset:1792
  ds_read_b32 v192, v10 offset:2048
  ds_read_b32 v193, v10 offset:2304
  ds_read_b32 v194, v10 offset:2560
  ds_read_b32 v195, v10 offset:2816
  ds_read_b32 v200, v10 offset:3072
  ds_read_b32 v201, v10 offset:3328
  ds_read_b32 v202, v10 offset:3584
  ds_read_b32 v203, v10 offset:3840
  ds_read_b32 v204, v10 offset:4096
  ds_read_b32 v205, v10 offset:4352
  ds_read_b32 v206, v10 offset:4608
  ds_read_b32 v207, v10 offset:4864
  ds_read_b32 v208, v10 offset:5120
  ds_read_b32 v209, v10 offset:5376
  ds_read_b32 v210, v10 offset:5632
  ds_read_b32 v211, v10 offset:5888
  s_waitcnt lgkmcnt(0)
  v_pk_add_f32 v[152:153], v[152:153], v[184:185]
  v_pk_add_f32 v[154:155], v[154:155], v[186:187]
  v_pk_add_f32 v[156:157], v[156:157], v[188:189]
  v_pk_add_f32 v[158:159], v[158:159], v[190:191]
  v_pk_add_f32 v[160:161], v[160:161], v[192:193]
  v_pk_add_f32 v[162:163], v[162:163], v[194:195]
  v_pk_add_f32 v[168:169], v[168:169], v[200:201]
  v_pk_add_f32 v[170:171], v[170:171], v[202:203]
  v_pk_add_f32 v[172:173], v[172:173], v[204:205]
  v_pk_add_f32 v[174:175], v[174:175], v[206:207]
  v_pk_add_f32 v[176:177], v[176:177], v[208:209]
  v_pk_add_f32 v[178:179], v[178:179], v[210:211]
  v_mov_b32 v216, v160
  v_mov_b32 v217, v160
  s_nop 1
  v_permlane32_swap_b32 v216, v217
  s_nop 1
  v_rcp_f32 v216, v217
  s_nop 0
  v_mul_f32 v216, v216, v240
  v_mul_f32 v152, v152, v216
  v_mul_f32 v153, v153, v216
  v_mul_f32 v154, v154, v216
  v_mul_f32 v155, v155, v216
  v_mul_f32 v156, v156, v216
  v_mul_f32 v157, v157, v216
  v_mul_f32 v158, v158, v216
  v_mul_f32 v159, v159, v216
  v_mul_f32 v160, v160, v216
  v_mul_f32 v161, v161, v216
  v_mul_f32 v162, v162, v216
  v_mul_f32 v163, v163, v216
  v_cvt_pk_bf16_f32 v224, v152, v153
  v_cvt_pk_bf16_f32 v225, v154, v155
  v_cvt_pk_bf16_f32 v226, v156, v157
  v_cvt_pk_bf16_f32 v227, v158, v159
  v_cvt_pk_bf16_f32 v232, v160, v161
  v_cvt_pk_bf16_f32 v233, v162, v163
  buffer_store_dwordx4 v[224:227], v12, s[16:19], s37 offen offset:0 sc1
  v_mov_b32 v218, v176
  v_mov_b32 v219, v176
  s_nop 1
  v_permlane32_swap_b32 v218, v219
  s_nop 1
  v_rcp_f32 v218, v219
  s_nop 0
  v_mul_f32 v218, v218, v240
  v_mul_f32 v168, v168, v218
  v_mul_f32 v169, v169, v218
  v_mul_f32 v170, v170, v218
  v_mul_f32 v171, v171, v218
  v_mul_f32 v172, v172, v218
  v_mul_f32 v173, v173, v218
  v_mul_f32 v174, v174, v218
  v_mul_f32 v175, v175, v218
  v_mul_f32 v176, v176, v218
  v_mul_f32 v177, v177, v218
  v_mul_f32 v178, v178, v218
  v_mul_f32 v179, v179, v218
  v_cvt_pk_bf16_f32 v228, v168, v169
  v_cvt_pk_bf16_f32 v229, v170, v171
  v_cvt_pk_bf16_f32 v230, v172, v173
  v_cvt_pk_bf16_f32 v231, v174, v175
  v_cvt_pk_bf16_f32 v234, v176, v177
  v_cvt_pk_bf16_f32 v235, v178, v179
  buffer_store_dwordx4 v[228:231], v12, s[16:19], s37 offen offset:512 sc1
  v_cmp_gt_u32 vcc, 32, v1
  s_and_saveexec_b64 s[40:41], vcc
  buffer_store_dwordx4 v[232:235], v11, s[16:19], s37 offen offset:1024 sc1
  s_mov_b64 exec, s[40:41]
  s_branch kd_kernel_end
kd_kernel_gemm:
  s_sub_u32 s50, s20, 4
  s_and_b32 s21, s2, 7
  s_lshr_b32 s22, s2, 3
  s_lshr_b32 s23, s21, 1
  s_lshl_b32 s23, s23, 3
  s_and_b32 s24, s22, 7
  s_add_u32 s23, s23, s24
  s_and_b32 s24, s21, 1
  s_lshl_b32 s24, s24, 2
  s_lshr_b32 s25, s22, 3
  s_add_u32 s24, s24, s25
  v_lshlrev_b32 v2, 4, v1
  v_mov_b32 v4, 106496
  v_mov_b32 v8, 0
  v_mov_b32 v9, 0
  v_mov_b32 v10, 0
  v_mov_b32 v11, 0
  ds_write_b128 v4, v[8:11]
  ds_write_b128 v4, v[8:11] offset:16
  s_mul_i32 s29, s50, 12
  s_lshl_b32 s27, s29, 10
  s_add_u32 s27, s27, 3145728
  s_lshl_b32 s30, s23, 2
  s_mul_i32 s30, s30, 49152
  s_add_u32 s40, s27, s30
  s_add_u32 s41, s40, 49152
  s_add_u32 s42, s41, 49152
  s_add_u32 s43, s42, 49152
  s_mul_i32 s28, s29, 40960
  s_mul_i32 s30, s24, 5120
  s_add_u32 s44, s28, s30
  s_add_u32 s44, s44, 12582912
  s_add_u32 s45, s44, 4096
  s_lshl_b32 s31, s23, 8
  s_lshl_b32 s32, s50, 6
  s_add_u32 s31, s31, s32
  s_add_u32 s31, s31, 2854912
  v_and_b32 v3, 15, v1
  v_lshlrev_b32 v5, 2, v3
  s_waitcnt lgkmcnt(0)
  s_mov_b32 s16, s60
  s_and_b32 s17, s61, 0xffff
  s_mov_b32 s18, 23068672
  s_mov_b32 s19, 0x20000
  s_barrier
  buffer_load_dword v6, v5, s[16:19], s31 offen
  buffer_load_dwordx4 v[112:115], v2, s[16:19], s44 offen offset:0
  buffer_load_dwordx4 v[116:119], v2, s[16:19], s44 offen offset:1024
  buffer_load_dwordx4 v[120:123], v2, s[16:19], s44 offen offset:2048
  buffer_load_dwordx4 v[124:127], v2, s[16:19], s44 offen offset:3072
  buffer_load_dwordx4 v[128:131], v2, s[16:19], s45 offen offset:0
  buffer_load_dwordx4 v[96:99], v2, s[16:19], s40 offen offset:0
  buffer_load_dwordx4 v[100:103], v2, s[16:19], s41 offen offset:0
  buffer_load_dwordx4 v[104:107], v2, s[16:19], s42 offen offset:0
  buffer_load_dwordx4 v[108:111], v2, s[16:19], s43 offen offset:0
  s_add_u32 s44, s44, 40960
  s_add_u32 s45, s45, 40960
  buffer_load_dwordx4 v[148:151], v2, s[16:19], s44 offen offset:0
  buffer_load_dwordx4 v[152:155], v2, s[16:19], s44 offen offset:1024
  buffer_load_dwordx4 v[156:159], v2, s[16:19], s44 offen offset:2048
  buffer_load_dwordx4 v[160:163], v2, s[16:19], s44 offen offset:3072
  buffer_load_dwordx4 v[164:167], v2, s[16:19], s45 offen offset:0
  buffer_load_dwordx4 v[132:135], v2, s[16:19], s40 offen offset:1024
  buffer_load_dwordx4 v[136:139], v2, s[16:19], s41 offen offset:1024
  buffer_load_dwordx4 v[140:143], v2, s[16:19], s42 offen offset:1024
  buffer_load_dwordx4 v[144:147], v2, s[16:19], s43 offen offset:1024
  s_add_u32 s44, s44, 40960
  s_add_u32 s45, s45, 40960
  buffer_load_dwordx4 v[184:187], v2, s[16:19], s44 offen offset:0
  buffer_load_dwordx4 v[188:191], v2, s[16:19], s44 offen offset:1024
  buffer_load_dwordx4 v[192:195], v2, s[16:19], s44 offen offset:2048
  buffer_load_dwordx4 v[196:199], v2, s[16:19], s44 offen offset:3072
  buffer_load_dwordx4 v[200:203], v2, s[16:19], s45 offen offset:0
  buffer_load_dwordx4 v[168:171], v2, s[16:19], s40 offen offset:2048
  buffer_load_dwordx4 v[172:175], v2, s[16:19], s41 offen offset:2048
  buffer_load_dwordx4 v[176:179], v2, s[16:19], s42 offen offset:2048
  buffer_load_dwordx4 v[180:183], v2, s[16:19], s43 offen offset:2048
  s_add_u32 s44, s44, 40960
  s_add_u32 s45, s45, 40960
  s_waitcnt vmcnt(18)
  v_mfma_f32_16x16x32_bf16 v[16:19], v[112:115], v[96:99], 0
  s_nop 9
  v_mfma_f32_16x16x32_bf16 v[20:23], v[116:119], v[96:99], 0
  s_nop 9
  buffer_load_dwordx4 v[220:223], v2, s[16:19], s44 offen offset:0
  v_mfma_f32_16x16x32_bf16 v[24:27], v[120:123], v[96:99], 0
  s_nop 9
  v_mfma_f32_16x16x32_bf16 v[28:31], v[124:127], v[96:99], 0
  s_nop 9
  buffer_load_dwordx4 v[224:227], v2, s[16:19], s44 offen offset:1024
  v_mfma_f32_16x16x32_bf16 v[32:35], v[128:131], v[96:99], 0
  s_nop 9
  v_mfma_f32_16x16x32_bf16 v[36:39], v[112:115], v[100:103], 0
  s_nop 9
  buffer_load_dwordx4 v[228:231], v2, s[16:19], s44 offen offset:2048
  v_mfma_f32_16x16x32_bf16 v[40:43], v[116:119], v[100:103], 0
  s_nop 9
  v_mfma_f32_16x16x32_bf16 v[44:47], v[120:123], v[100:103], 0
  s_nop 9
  buffer_load_dwordx4 v[232:235], v2, s[16:19], s44 offen offset:3072
  v_mfma_f32_16x16x32_bf16 v[48:51], v[124:127], v[100:103], 0
  s_nop 9
  v_mfma_f32_16x16x32_bf16 v[52:55], v[128:131], v[100:103], 0
  s_nop 9
  buffer_load_dwordx4 v[236:239], v2, s[16:19], s45 offen offset:0
  v_mfma_f32_16x16x32_bf16 v[56:59], v[112:115], v[104:107], 0
  s_nop 9
  v_mfma_f32_16x16x32_bf16 v[60:63], v[116:119], v[104:107], 0
  s_nop 9
  buffer_load_dwordx4 v[204:207], v2, s[16:19], s40 offen offset:3072
  v_mfma_f32_16x16x32_bf16 v[64:67], v[120:123], v[104:107], 0
  s_nop 9
  v_mfma_f32_16x16x32_bf16 v[68:71], v[124:127], v[104:107], 0
  s_nop 9
  buffer_load_dwordx4 v[208:211], v2, s[16:19], s41 offen offset:3072
  v_mfma_f32_16x16x32_bf16 v[72:75], v[128:131], v[104:107], 0
  s_nop 9
  v_mfma_f32_16x16x32_bf16 v[76:79], v[112:115], v[108:111], 0
  s_nop 9
  buffer_load_dwordx4 v[212:215], v2, s[16:19], s42 offen offset:3072
  v_mfma_f32_16x16x32_bf16 v[80:83], v[116:119], v[108:111], 0
  s_nop 9
  v_mfma_f32_16x16x32_bf16 v[84:87], v[120:123], v[108:111], 0
  s_nop 9
  buffer_load_dwordx4 v[216:219], v2, s[16:19], s43 offen offset:3072
  v_mfma_f32_16x16x32_bf16 v[88:91], v[124:127], v[108:111], 0
  s_nop 9
  v_mfma_f32_16x16x32_bf16 v[92:95], v[128:131], v[108:111], 0
  s_nop 9
  s_add_u32 s44, s44, 40960
  s_add_u32 s45, s45, 40960
  s_add_u32 s40, s40, 4096
  s_add_u32 s41, s41, 4096
  s_add_u32 s42, s42, 4096
  s_add_u32 s43, s43, 4096
  s_waitcnt vmcnt(18)
  v_mfma_f32_16x16x32_bf16 v[16:19], v[148:151], v[132:135], v[16:19]
  s_nop 9
  v_mfma_f32_16x16x32_bf16 v[20:23], v[152:155], v[132:135], v[20:23]
  s_nop 9
  buffer_load_dwordx4 v[112:115], v2, s[16:19], s44 offen offset:0
  v_mfma_f32_16x16x32_bf16 v[24:27], v[156:159], v[132:135], v[24:27]
  s_nop 9
  v_mfma_f32_16x16x32_bf16 v[28:31], v[160:163], v[132:135], v[28:31]
  s_nop 9
  buffer_load_dwordx4 v[116:119], v2, s[16:19], s44 offen offset:1024
  v_mfma_f32_16x16x32_bf16 v[32:35], v[164:167], v[132:135], v[32:35]
  s_nop 9
  v_mfma_f32_16x16x32_bf16 v[36:39], v[148:151], v[136:139], v[36:39]
  s_nop 9
  buffer_load_dwordx4 v[120:123], v2, s[16:19], s44 offen offset:2048
  v_mfma_f32_16x16x32_bf16 v[40:43], v[152:155], v[136:139], v[40:43]
  s_nop 9
  v_mfma_f32_16x16x32_bf16 v[44:47], v[156:159], v[136:139], v[44:47]
  s_nop 9
  buffer_load_dwordx4 v[124:127], v2, s[16:19], s44 offen offset:3072
  v_mfma_f32_16x16x32_bf16 v[48:51], v[160:163], v[136:139], v[48:51]
  s_nop 9
  v_mfma_f32_16x16x32_bf16 v[52:55], v[164:167], v[136:139], v[52:55]
  s_nop 9
  buffer_load_dwordx4 v[128:131], v2, s[16:19], s45 offen offset:0
  v_mfma_f32_16x16x32_bf16 v[56:59], v[148:151], v[140:143], v[56:59]
  s_nop 9
  v_mfma_f32_16x16x32_bf16 v[60:63], v[152:155], v[140:143], v[60:63]
  s_nop 9
  buffer_load_dwordx4 v[96:99], v2, s[16:19], s40 offen offset:0
  v_mfma_f32_16x16x32_bf16 v[64:67], v[156:159], v[140:143], v[64:67]
  s_nop 9
  v_mfma_f32_16x16x32_bf16 v[68:71], v[160:163], v[140:143], v[68:71]
  s_nop 9
  buffer_load_dwordx4 v[100:103], v2, s[16:19], s41 offen offset:0
  v_mfma_f32_16x16x32_bf16 v[72:75], v[164:167], v[140:143], v[72:75]
  s_nop 9
  v_mfma_f32_16x16x32_bf16 v[76:79], v[148:151], v[144:147], v[76:79]
  s_nop 9
  buffer_load_dwordx4 v[104:107], v2, s[16:19], s42 offen offset:0
  v_mfma_f32_16x16x32_bf16 v[80:83], v[152:155], v[144:147], v[80:83]
  s_nop 9
  v_mfma_f32_16x16x32_bf16 v[84:87], v[156:159], v[144:147], v[84:87]
  s_nop 9
  buffer_load_dwordx4 v[108:111], v2, s[16:19], s43 offen offset:0
  v_mfma_f32_16x16x32_bf16 v[88:91], v[160:163], v[144:147], v[88:91]
  s_nop 9
  v_mfma_f32_16x16x32_bf16 v[92:95], v[164:167], v[144:147], v[92:95]
  s_nop 9
  s_add_u32 s44, s44, 40960
  s_add_u32 s45, s45, 40960
  s_waitcnt vmcnt(18)
  v_mfma_f32_16x16x32_bf16 v[16:19], v[184:187], v[168:171], v[16:19]
  s_nop 9
  v_mfma_f32_16x16x32_bf16 v[20:23], v[188:191], v[168:171], v[20:23]
  s_nop 9
  buffer_load_dwordx4 v[148:151], v2, s[16:19], s44 offen offset:0
  v_mfma_f32_16x16x32_bf16 v[24:27], v[192:195], v[168:171], v[24:27]
  s_nop 9
  v_mfma_f32_16x16x32_bf16 v[28:31], v[196:199], v[168:171], v[28:31]
  s_nop 9
  buffer_load_dwordx4 v[152:155], v2, s[16:19], s44 offen offset:1024
  v_mfma_f32_16x16x32_bf16 v[32:35], v[200:203], v[168:171], v[32:35]
  s_nop 9
  v_mfma_f32_16x16x32_bf16 v[36:39], v[184:187], v[172:175], v[36:39]
  s_nop 9
  buffer_load_dwordx4 v[156:159], v2, s[16:19], s44 offen offset:2048
  v_mfma_f32_16x16x32_bf16 v[40:43], v[188:191], v[172:175], v[40:43]
  s_nop 9
  v_mfma_f32_16x16x32_bf16 v[44:47], v[192:195], v[172:175], v[44:47]
  s_nop 9
  buffer_load_dwordx4 v[160:163], v2, s[16:19], s44 offen offset:3072
  v_mfma_f32_16x16x32_bf16 v[48:51], v[196:199], v[172:175], v[48:51]
  s_nop 9
  v_mfma_f32_16x16x32_bf16 v[52:55], v[200:203], v[172:175], v[52:55]
  s_nop 9
  buffer_load_dwordx4 v[164:167], v2, s[16:19], s45 offen offset:0
  v_mfma_f32_16x16x32_bf16 v[56:59], v[184:187], v[176:179], v[56:59]
  s_nop 9
  v_mfma_f32_16x16x32_bf16 v[60:63], v[188:191], v[176:179], v[60:63]
  s_nop 9
  buffer_load_dwordx4 v[132:135], v2, s[16:19], s40 offen offset:1024
  v_mfma_f32_16x16x32_bf16 v[64:67], v[192:195], v[176:179], v[64:67]
  s_nop 9
  v_mfma_f32_16x16x32_bf16 v[68:71], v[196:199], v[176:179], v[68:71]
  s_nop 9
  buffer_load_dwordx4 v[136:139], v2, s[16:19], s41 offen offset:1024
  v_mfma_f32_16x16x32_bf16 v[72:75], v[200:203], v[176:179], v[72:75]
  s_nop 9
  v_mfma_f32_16x16x32_bf16 v[76:79], v[184:187], v[180:183], v[76:79]
  s_nop 9
  buffer_load_dwordx4 v[140:143], v2, s[16:19], s42 offen offset:1024
  v_mfma_f32_16x16x32_bf16 v[80:83], v[188:191], v[180:183], v[80:83]
  s_nop 9
  v_mfma_f32_16x16x32_bf16 v[84:87], v[192:195], v[180:183], v[84:87]
  s_nop 9
  buffer_load_dwordx4 v[144:147], v2, s[16:19], s43 offen offset:1024
  v_mfma_f32_16x16x32_bf16 v[88:91], v[196:199], v[180:183], v[88:91]
  s_nop 9
  v_mfma_f32_16x16x32_bf16 v[92:95], v[200:203], v[180:183], v[92:95]
  s_nop 9
  s_add_u32 s44, s44, 40960
  s_add_u32 s45, s45, 40960
  s_waitcnt vmcnt(18)
  v_mfma_f32_16x16x32_bf16 v[16:19], v[220:223], v[204:207], v[16:19]
  s_nop 9
  v_mfma_f32_16x16x32_bf16 v[20:23], v[224:227], v[204:207], v[20:23]
  s_nop 9
  buffer_load_dwordx4 v[184:187], v2, s[16:19], s44 offen offset:0
  v_mfma_f32_16x16x32_bf16 v[24:27], v[228:231], v[204:207], v[24:27]
  s_nop 9
  v_mfma_f32_16x16x32_bf16 v[28:31], v[232:235], v[204:207], v[28:31]
  s_nop 9
  buffer_load_dwordx4 v[188:191], v2, s[16:19], s44 offen offset:1024
  v_mfma_f32_16x16x32_bf16 v[32:35], v[236:239], v[204:207], v[32:35]
  s_nop 9
  v_mfma_f32_16x16x32_bf16 v[36:39], v[220:223], v[208:211], v[36:39]
  s_nop 9
  buffer_load_dwordx4 v[192:195], v2, s[16:19], s44 offen offset:2048
  v_mfma_f32_16x16x32_bf16 v[40:43], v[224:227], v[208:211], v[40:43]
  s_nop 9
  v_mfma_f32_16x16x32_bf16 v[44:47], v[228:231], v[208:211], v[44:47]
  s_nop 9
  buffer_load_dwordx4 v[196:199], v2, s[16:19], s44 offen offset:3072
  v_mfma_f32_16x16x32_bf16 v[48:51], v[232:235], v[208:211], v[48:51]
  s_nop 9
  v_mfma_f32_16x16x32_bf16 v[52:55], v[236:239], v[208:211], v[52:55]
  s_nop 9
  buffer_load_dwordx4 v[200:203], v2, s[16:19], s45 offen offset:0
  v_mfma_f32_16x16x32_bf16 v[56:59], v[220:223], v[212:215], v[56:59]
  s_nop 9
  v_mfma_f32_16x16x32_bf16 v[60:63], v[224:227], v[212:215], v[60:63]
  s_nop 9
  buffer_load_dwordx4 v[168:171], v2, s[16:19], s40 offen offset:2048
  v_mfma_f32_16x16x32_bf16 v[64:67], v[228:231], v[212:215], v[64:67]
  s_nop 9
  v_mfma_f32_16x16x32_bf16 v[68:71], v[232:235], v[212:215], v[68:71]
  s_nop 9
  buffer_load_dwordx4 v[172:175], v2, s[16:19], s41 offen offset:2048
  v_mfma_f32_16x16x32_bf16 v[72:75], v[236:239], v[212:215], v[72:75]
  s_nop 9
  v_mfma_f32_16x16x32_bf16 v[76:79], v[220:223], v[216:219], v[76:79]
  s_nop 9
  buffer_load_dwordx4 v[176:179], v2, s[16:19], s42 offen offset:2048
  v_mfma_f32_16x16x32_bf16 v[80:83], v[224:227], v[216:219], v[80:83]
  s_nop 9
  v_mfma_f32_16x16x32_bf16 v[84:87], v[228:231], v[216:219], v[84:87]
  s_nop 9
  buffer_load_dwordx4 v[180:183], v2, s[16:19], s43 offen offset:2048
  v_mfma_f32_16x16x32_bf16 v[88:91], v[232:235], v[216:219], v[88:91]
  s_nop 9
  v_mfma_f32_16x16x32_bf16 v[92:95], v[236:239], v[216:219], v[92:95]
  s_nop 9
  s_add_u32 s44, s44, 40960
  s_add_u32 s45, s45, 40960
  s_waitcnt vmcnt(18)
  v_mfma_f32_16x16x32_bf16 v[16:19], v[112:115], v[96:99], v[16:19]
  s_nop 9
  v_mfma_f32_16x16x32_bf16 v[20:23], v[116:119], v[96:99], v[20:23]
  s_nop 9
  buffer_load_dwordx4 v[220:223], v2, s[16:19], s44 offen offset:0
  v_mfma_f32_16x16x32_bf16 v[24:27], v[120:123], v[96:99], v[24:27]
  s_nop 9
  v_mfma_f32_16x16x32_bf16 v[28:31], v[124:127], v[96:99], v[28:31]
  s_nop 9
  buffer_load_dwordx4 v[224:227], v2, s[16:19], s44 offen offset:1024
  v_mfma_f32_16x16x32_bf16 v[32:35], v[128:131], v[96:99], v[32:35]
  s_nop 9
  v_mfma_f32_16x16x32_bf16 v[36:39], v[112:115], v[100:103], v[36:39]
  s_nop 9
  buffer_load_dwordx4 v[228:231], v2, s[16:19], s44 offen offset:2048
  v_mfma_f32_16x16x32_bf16 v[40:43], v[116:119], v[100:103], v[40:43]
  s_nop 9
  v_mfma_f32_16x16x32_bf16 v[44:47], v[120:123], v[100:103], v[44:47]
  s_nop 9
  buffer_load_dwordx4 v[232:235], v2, s[16:19], s44 offen offset:3072
  v_mfma_f32_16x16x32_bf16 v[48:51], v[124:127], v[100:103], v[48:51]
  s_nop 9
  v_mfma_f32_16x16x32_bf16 v[52:55], v[128:131], v[100:103], v[52:55]
  s_nop 9
  buffer_load_dwordx4 v[236:239], v2, s[16:19], s45 offen offset:0
  v_mfma_f32_16x16x32_bf16 v[56:59], v[112:115], v[104:107], v[56:59]
  s_nop 9
  v_mfma_f32_16x16x32_bf16 v[60:63], v[116:119], v[104:107], v[60:63]
  s_nop 9
  buffer_load_dwordx4 v[204:207], v2, s[16:19], s40 offen offset:3072
  v_mfma_f32_16x16x32_bf16 v[64:67], v[120:123], v[104:107], v[64:67]
  s_nop 9
  v_mfma_f32_16x16x32_bf16 v[68:71], v[124:127], v[104:107], v[68:71]
  s_nop 9
  buffer_load_dwordx4 v[208:211], v2, s[16:19], s41 offen offset:3072
  v_mfma_f32_16x16x32_bf16 v[72:75], v[128:131], v[104:107], v[72:75]
  s_nop 9
  v_mfma_f32_16x16x32_bf16 v[76:79], v[112:115], v[108:111], v[76:79]
  s_nop 9
  buffer_load_dwordx4 v[212:215], v2, s[16:19], s42 offen offset:3072
  v_mfma_f32_16x16x32_bf16 v[80:83], v[116:119], v[108:111], v[80:83]
  s_nop 9
  v_mfma_f32_16x16x32_bf16 v[84:87], v[120:123], v[108:111], v[84:87]
  s_nop 9
  buffer_load_dwordx4 v[216:219], v2, s[16:19], s43 offen offset:3072
  v_mfma_f32_16x16x32_bf16 v[88:91], v[124:127], v[108:111], v[88:91]
  s_nop 9
  v_mfma_f32_16x16x32_bf16 v[92:95], v[128:131], v[108:111], v[92:95]
  s_nop 9
  s_add_u32 s44, s44, 40960
  s_add_u32 s45, s45, 40960
  s_add_u32 s40, s40, 4096
  s_add_u32 s41, s41, 4096
  s_add_u32 s42, s42, 4096
  s_add_u32 s43, s43, 4096
  s_waitcnt vmcnt(18)
  v_mfma_f32_16x16x32_bf16 v[16:19], v[148:151], v[132:135], v[16:19]
  s_nop 9
  v_mfma_f32_16x16x32_bf16 v[20:23], v[152:155], v[132:135], v[20:23]
  s_nop 9
  buffer_load_dwordx4 v[112:115], v2, s[16:19], s44 offen offset:0
  v_mfma_f32_16x16x32_bf16 v[24:27], v[156:159], v[132:135], v[24:27]
  s_nop 9
  v_mfma_f32_16x16x32_bf16 v[28:31], v[160:163], v[132:135], v[28:31]
  s_nop 9
  buffer_load_dwordx4 v[116:119], v2, s[16:19], s44 offen offset:1024
  v_mfma_f32_16x16x32_bf16 v[32:35], v[164:167], v[132:135], v[32:35]
  s_nop 9
  v_mfma_f32_16x16x32_bf16 v[36:39], v[148:151], v[136:139], v[36:39]
  s_nop 9
  buffer_load_dwordx4 v[120:123], v2, s[16:19], s44 offen offset:2048
  v_mfma_f32_16x16x32_bf16 v[40:43], v[152:155], v[136:139], v[40:43]
  s_nop 9
  v_mfma_f32_16x16x32_bf16 v[44:47], v[156:159], v[136:139], v[44:47]
  s_nop 9
  buffer_load_dwordx4 v[124:127], v2, s[16:19], s44 offen offset:3072
  v_mfma_f32_16x16x32_bf16 v[48:51], v[160:163], v[136:139], v[48:51]
  s_nop 9
  v_mfma_f32_16x16x32_bf16 v[52:55], v[164:167], v[136:139], v[52:55]
  s_nop 9
  buffer_load_dwordx4 v[128:131], v2, s[16:19], s45 offen offset:0
  v_mfma_f32_16x16x32_bf16 v[56:59], v[148:151], v[140:143], v[56:59]
  s_nop 9
  v_mfma_f32_16x16x32_bf16 v[60:63], v[152:155], v[140:143], v[60:63]
  s_nop 9
  buffer_load_dwordx4 v[96:99], v2, s[16:19], s40 offen offset:0
  v_mfma_f32_16x16x32_bf16 v[64:67], v[156:159], v[140:143], v[64:67]
  s_nop 9
  v_mfma_f32_16x16x32_bf16 v[68:71], v[160:163], v[140:143], v[68:71]
  s_nop 9
  buffer_load_dwordx4 v[100:103], v2, s[16:19], s41 offen offset:0
  v_mfma_f32_16x16x32_bf16 v[72:75], v[164:167], v[140:143], v[72:75]
  s_nop 9
  v_mfma_f32_16x16x32_bf16 v[76:79], v[148:151], v[144:147], v[76:79]
  s_nop 9
  buffer_load_dwordx4 v[104:107], v2, s[16:19], s42 offen offset:0
  v_mfma_f32_16x16x32_bf16 v[80:83], v[152:155], v[144:147], v[80:83]
  s_nop 9
  v_mfma_f32_16x16x32_bf16 v[84:87], v[156:159], v[144:147], v[84:87]
  s_nop 9
  buffer_load_dwordx4 v[108:111], v2, s[16:19], s43 offen offset:0
  v_mfma_f32_16x16x32_bf16 v[88:91], v[160:163], v[144:147], v[88:91]
  s_nop 9
  v_mfma_f32_16x16x32_bf16 v[92:95], v[164:167], v[144:147], v[92:95]
  s_nop 9
  s_add_u32 s44, s44, 40960
  s_add_u32 s45, s45, 40960
  s_waitcnt vmcnt(18)
  v_mfma_f32_16x16x32_bf16 v[16:19], v[184:187], v[168:171], v[16:19]
  s_nop 9
  v_mfma_f32_16x16x32_bf16 v[20:23], v[188:191], v[168:171], v[20:23]
  s_nop 9
  buffer_load_dwordx4 v[148:151], v2, s[16:19], s44 offen offset:0
  v_mfma_f32_16x16x32_bf16 v[24:27], v[192:195], v[168:171], v[24:27]
  s_nop 9
  v_mfma_f32_16x16x32_bf16 v[28:31], v[196:199], v[168:171], v[28:31]
  s_nop 9
  buffer_load_dwordx4 v[152:155], v2, s[16:19], s44 offen offset:1024
  v_mfma_f32_16x16x32_bf16 v[32:35], v[200:203], v[168:171], v[32:35]
  s_nop 9
  v_mfma_f32_16x16x32_bf16 v[36:39], v[184:187], v[172:175], v[36:39]
  s_nop 9
  buffer_load_dwordx4 v[156:159], v2, s[16:19], s44 offen offset:2048
  v_mfma_f32_16x16x32_bf16 v[40:43], v[188:191], v[172:175], v[40:43]
  s_nop 9
  v_mfma_f32_16x16x32_bf16 v[44:47], v[192:195], v[172:175], v[44:47]
  s_nop 9
  buffer_load_dwordx4 v[160:163], v2, s[16:19], s44 offen offset:3072
  v_mfma_f32_16x16x32_bf16 v[48:51], v[196:199], v[172:175], v[48:51]
  s_nop 9
  v_mfma_f32_16x16x32_bf16 v[52:55], v[200:203], v[172:175], v[52:55]
  s_nop 9
  buffer_load_dwordx4 v[164:167], v2, s[16:19], s45 offen offset:0
  v_mfma_f32_16x16x32_bf16 v[56:59], v[184:187], v[176:179], v[56:59]
  s_nop 9
  v_mfma_f32_16x16x32_bf16 v[60:63], v[188:191], v[176:179], v[60:63]
  s_nop 9
  buffer_load_dwordx4 v[132:135], v2, s[16:19], s40 offen offset:1024
  v_mfma_f32_16x16x32_bf16 v[64:67], v[192:195], v[176:179], v[64:67]
  s_nop 9
  v_mfma_f32_16x16x32_bf16 v[68:71], v[196:199], v[176:179], v[68:71]
  s_nop 9
  buffer_load_dwordx4 v[136:139], v2, s[16:19], s41 offen offset:1024
  v_mfma_f32_16x16x32_bf16 v[72:75], v[200:203], v[176:179], v[72:75]
  s_nop 9
  v_mfma_f32_16x16x32_bf16 v[76:79], v[184:187], v[180:183], v[76:79]
  s_nop 9
  buffer_load_dwordx4 v[140:143], v2, s[16:19], s42 offen offset:1024
  v_mfma_f32_16x16x32_bf16 v[80:83], v[188:191], v[180:183], v[80:83]
  s_nop 9
  v_mfma_f32_16x16x32_bf16 v[84:87], v[192:195], v[180:183], v[84:87]
  s_nop 9
  buffer_load_dwordx4 v[144:147], v2, s[16:19], s43 offen offset:1024
  v_mfma_f32_16x16x32_bf16 v[88:91], v[196:199], v[180:183], v[88:91]
  s_nop 9
  v_mfma_f32_16x16x32_bf16 v[92:95], v[200:203], v[180:183], v[92:95]
  s_nop 9
  s_add_u32 s44, s44, 40960
  s_add_u32 s45, s45, 40960
  s_waitcnt vmcnt(18)
  v_mfma_f32_16x16x32_bf16 v[16:19], v[220:223], v[204:207], v[16:19]
  s_nop 9
  v_mfma_f32_16x16x32_bf16 v[20:23], v[224:227], v[204:207], v[20:23]
  s_nop 9
  buffer_load_dwordx4 v[184:187], v2, s[16:19], s44 offen offset:0
  v_mfma_f32_16x16x32_bf16 v[24:27], v[228:231], v[204:207], v[24:27]
  s_nop 9
  v_mfma_f32_16x16x32_bf16 v[28:31], v[232:235], v[204:207], v[28:31]
  s_nop 9
  buffer_load_dwordx4 v[188:191], v2, s[16:19], s44 offen offset:1024
  v_mfma_f32_16x16x32_bf16 v[32:35], v[236:239], v[204:207], v[32:35]
  s_nop 9
  v_mfma_f32_16x16x32_bf16 v[36:39], v[220:223], v[208:211], v[36:39]
  s_nop 9
  buffer_load_dwordx4 v[192:195], v2, s[16:19], s44 offen offset:2048
  v_mfma_f32_16x16x32_bf16 v[40:43], v[224:227], v[208:211], v[40:43]
  s_nop 9
  v_mfma_f32_16x16x32_bf16 v[44:47], v[228:231], v[208:211], v[44:47]
  s_nop 9
  buffer_load_dwordx4 v[196:199], v2, s[16:19], s44 offen offset:3072
  v_mfma_f32_16x16x32_bf16 v[48:51], v[232:235], v[208:211], v[48:51]
  s_nop 9
  v_mfma_f32_16x16x32_bf16 v[52:55], v[236:239], v[208:211], v[52:55]
  s_nop 9
  buffer_load_dwordx4 v[200:203], v2, s[16:19], s45 offen offset:0
  v_mfma_f32_16x16x32_bf16 v[56:59], v[220:223], v[212:215], v[56:59]
  s_nop 9
  v_mfma_f32_16x16x32_bf16 v[60:63], v[224:227], v[212:215], v[60:63]
  s_nop 9
  buffer_load_dwordx4 v[168:171], v2, s[16:19], s40 offen offset:2048
  v_mfma_f32_16x16x32_bf16 v[64:67], v[228:231], v[212:215], v[64:67]
  s_nop 9
  v_mfma_f32_16x16x32_bf16 v[68:71], v[232:235], v[212:215], v[68:71]
  s_nop 9
  buffer_load_dwordx4 v[172:175], v2, s[16:19], s41 offen offset:2048
  v_mfma_f32_16x16x32_bf16 v[72:75], v[236:239], v[212:215], v[72:75]
  s_nop 9
  v_mfma_f32_16x16x32_bf16 v[76:79], v[220:223], v[216:219], v[76:79]
  s_nop 9
  buffer_load_dwordx4 v[176:179], v2, s[16:19], s42 offen offset:2048
  v_mfma_f32_16x16x32_bf16 v[80:83], v[224:227], v[216:219], v[80:83]
  s_nop 9
  v_mfma_f32_16x16x32_bf16 v[84:87], v[228:231], v[216:219], v[84:87]
  s_nop 9
  buffer_load_dwordx4 v[180:183], v2, s[16:19], s43 offen offset:2048
  v_mfma_f32_16x16x32_bf16 v[88:91], v[232:235], v[216:219], v[88:91]
  s_nop 9
  v_mfma_f32_16x16x32_bf16 v[92:95], v[236:239], v[216:219], v[92:95]
  s_nop 9
  s_add_u32 s44, s44, 40960
  s_add_u32 s45, s45, 40960
  s_waitcnt vmcnt(18)
  v_mfma_f32_16x16x32_bf16 v[16:19], v[112:115], v[96:99], v[16:19]
  s_nop 9
  v_mfma_f32_16x16x32_bf16 v[20:23], v[116:119], v[96:99], v[20:23]
  s_nop 9
  buffer_load_dwordx4 v[220:223], v2, s[16:19], s44 offen offset:0
  v_mfma_f32_16x16x32_bf16 v[24:27], v[120:123], v[96:99], v[24:27]
  s_nop 9
  v_mfma_f32_16x16x32_bf16 v[28:31], v[124:127], v[96:99], v[28:31]
  s_nop 9
  buffer_load_dwordx4 v[224:227], v2, s[16:19], s44 offen offset:1024
  v_mfma_f32_16x16x32_bf16 v[32:35], v[128:131], v[96:99], v[32:35]
  s_nop 9
  v_mfma_f32_16x16x32_bf16 v[36:39], v[112:115], v[100:103], v[36:39]
  s_nop 9
  buffer_load_dwordx4 v[228:231], v2, s[16:19], s44 offen offset:2048
  v_mfma_f32_16x16x32_bf16 v[40:43], v[116:119], v[100:103], v[40:43]
  s_nop 9
  v_mfma_f32_16x16x32_bf16 v[44:47], v[120:123], v[100:103], v[44:47]
  s_nop 9
  buffer_load_dwordx4 v[232:235], v2, s[16:19], s44 offen offset:3072
  v_mfma_f32_16x16x32_bf16 v[48:51], v[124:127], v[100:103], v[48:51]
  s_nop 9
  v_mfma_f32_16x16x32_bf16 v[52:55], v[128:131], v[100:103], v[52:55]
  s_nop 9
  buffer_load_dwordx4 v[236:239], v2, s[16:19], s45 offen offset:0
  v_mfma_f32_16x16x32_bf16 v[56:59], v[112:115], v[104:107], v[56:59]
  s_nop 9
  v_mfma_f32_16x16x32_bf16 v[60:63], v[116:119], v[104:107], v[60:63]
  s_nop 9
  buffer_load_dwordx4 v[204:207], v2, s[16:19], s40 offen offset:3072
  v_mfma_f32_16x16x32_bf16 v[64:67], v[120:123], v[104:107], v[64:67]
  s_nop 9
  v_mfma_f32_16x16x32_bf16 v[68:71], v[124:127], v[104:107], v[68:71]
  s_nop 9
  buffer_load_dwordx4 v[208:211], v2, s[16:19], s41 offen offset:3072
  v_mfma_f32_16x16x32_bf16 v[72:75], v[128:131], v[104:107], v[72:75]
  s_nop 9
  v_mfma_f32_16x16x32_bf16 v[76:79], v[112:115], v[108:111], v[76:79]
  s_nop 9
  buffer_load_dwordx4 v[212:215], v2, s[16:19], s42 offen offset:3072
  v_mfma_f32_16x16x32_bf16 v[80:83], v[116:119], v[108:111], v[80:83]
  s_nop 9
  v_mfma_f32_16x16x32_bf16 v[84:87], v[120:123], v[108:111], v[84:87]
  s_nop 9
  buffer_load_dwordx4 v[216:219], v2, s[16:19], s43 offen offset:3072
  v_mfma_f32_16x16x32_bf16 v[88:91], v[124:127], v[108:111], v[88:91]
  s_nop 9
  v_mfma_f32_16x16x32_bf16 v[92:95], v[128:131], v[108:111], v[92:95]
  s_nop 9
  s_add_u32 s44, s44, 40960
  s_add_u32 s45, s45, 40960
  s_add_u32 s40, s40, 4096
  s_add_u32 s41, s41, 4096
  s_add_u32 s42, s42, 4096
  s_add_u32 s43, s43, 4096
  s_waitcnt vmcnt(18)
  v_mfma_f32_16x16x32_bf16 v[16:19], v[148:151], v[132:135], v[16:19]
  s_nop 9
  v_mfma_f32_16x16x32_bf16 v[20:23], v[152:155], v[132:135], v[20:23]
  s_nop 9
  v_mfma_f32_16x16x32_bf16 v[24:27], v[156:159], v[132:135], v[24:27]
  s_nop 9
  v_mfma_f32_16x16x32_bf16 v[28:31], v[160:163], v[132:135], v[28:31]
  s_nop 9
  v_mfma_f32_16x16x32_bf16 v[32:35], v[164:167], v[132:135], v[32:35]
  s_nop 9
  v_mfma_f32_16x16x32_bf16 v[36:39], v[148:151], v[136:139], v[36:39]
  s_nop 9
  v_mfma_f32_16x16x32_bf16 v[40:43], v[152:155], v[136:139], v[40:43]
  s_nop 9
  v_mfma_f32_16x16x32_bf16 v[44:47], v[156:159], v[136:139], v[44:47]
  s_nop 9
  v_mfma_f32_16x16x32_bf16 v[48:51], v[160:163], v[136:139], v[48:51]
  s_nop 9
  v_mfma_f32_16x16x32_bf16 v[52:55], v[164:167], v[136:139], v[52:55]
  s_nop 9
  v_mfma_f32_16x16x32_bf16 v[56:59], v[148:151], v[140:143], v[56:59]
  s_nop 9
  v_mfma_f32_16x16x32_bf16 v[60:63], v[152:155], v[140:143], v[60:63]
  s_nop 9
  v_mfma_f32_16x16x32_bf16 v[64:67], v[156:159], v[140:143], v[64:67]
  s_nop 9
  v_mfma_f32_16x16x32_bf16 v[68:71], v[160:163], v[140:143], v[68:71]
  s_nop 9
  v_mfma_f32_16x16x32_bf16 v[72:75], v[164:167], v[140:143], v[72:75]
  s_nop 9
  v_mfma_f32_16x16x32_bf16 v[76:79], v[148:151], v[144:147], v[76:79]
  s_nop 9
  v_mfma_f32_16x16x32_bf16 v[80:83], v[152:155], v[144:147], v[80:83]
  s_nop 9
  v_mfma_f32_16x16x32_bf16 v[84:87], v[156:159], v[144:147], v[84:87]
  s_nop 9
  v_mfma_f32_16x16x32_bf16 v[88:91], v[160:163], v[144:147], v[88:91]
  s_nop 9
  v_mfma_f32_16x16x32_bf16 v[92:95], v[164:167], v[144:147], v[92:95]
  s_nop 9
  s_waitcnt vmcnt(9)
  v_mfma_f32_16x16x32_bf16 v[16:19], v[184:187], v[168:171], v[16:19]
  s_nop 9
  v_mfma_f32_16x16x32_bf16 v[20:23], v[188:191], v[168:171], v[20:23]
  s_nop 9
  v_mfma_f32_16x16x32_bf16 v[24:27], v[192:195], v[168:171], v[24:27]
  s_nop 9
  v_mfma_f32_16x16x32_bf16 v[28:31], v[196:199], v[168:171], v[28:31]
  s_nop 9
  v_mfma_f32_16x16x32_bf16 v[32:35], v[200:203], v[168:171], v[32:35]
  s_nop 9
  v_mfma_f32_16x16x32_bf16 v[36:39], v[184:187], v[172:175], v[36:39]
  s_nop 9
  v_mfma_f32_16x16x32_bf16 v[40:43], v[188:191], v[172:175], v[40:43]
  s_nop 9
  v_mfma_f32_16x16x32_bf16 v[44:47], v[192:195], v[172:175], v[44:47]
  s_nop 9
  v_mfma_f32_16x16x32_bf16 v[48:51], v[196:199], v[172:175], v[48:51]
  s_nop 9
  v_mfma_f32_16x16x32_bf16 v[52:55], v[200:203], v[172:175], v[52:55]
  s_nop 9
  v_mfma_f32_16x16x32_bf16 v[56:59], v[184:187], v[176:179], v[56:59]
  s_nop 9
  v_mfma_f32_16x16x32_bf16 v[60:63], v[188:191], v[176:179], v[60:63]
  s_nop 9
  v_mfma_f32_16x16x32_bf16 v[64:67], v[192:195], v[176:179], v[64:67]
  s_nop 9
  v_mfma_f32_16x16x32_bf16 v[68:71], v[196:199], v[176:179], v[68:71]
  s_nop 9
  v_mfma_f32_16x16x32_bf16 v[72:75], v[200:203], v[176:179], v[72:75]
  s_nop 9
  v_mfma_f32_16x16x32_bf16 v[76:79], v[184:187], v[180:183], v[76:79]
  s_nop 9
  v_mfma_f32_16x16x32_bf16 v[80:83], v[188:191], v[180:183], v[80:83]
  s_nop 9
  v_mfma_f32_16x16x32_bf16 v[84:87], v[192:195], v[180:183], v[84:87]
  s_nop 9
  v_mfma_f32_16x16x32_bf16 v[88:91], v[196:199], v[180:183], v[88:91]
  s_nop 9
  v_mfma_f32_16x16x32_bf16 v[92:95], v[200:203], v[180:183], v[92:95]
  s_nop 9
  s_waitcnt vmcnt(0)
  v_mfma_f32_16x16x32_bf16 v[16:19], v[220:223], v[204:207], v[16:19]
  s_nop 9
  v_mfma_f32_16x16x32_bf16 v[20:23], v[224:227], v[204:207], v[20:23]
  s_nop 9
  v_mfma_f32_16x16x32_bf16 v[24:27], v[228:231], v[204:207], v[24:27]
  s_nop 9
  v_mfma_f32_16x16x32_bf16 v[28:31], v[232:235], v[204:207], v[28:31]
  s_nop 9
  v_mfma_f32_16x16x32_bf16 v[32:35], v[236:239], v[204:207], v[32:35]
  s_nop 9
  v_mfma_f32_16x16x32_bf16 v[36:39], v[220:223], v[208:211], v[36:39]
  s_nop 9
  v_mfma_f32_16x16x32_bf16 v[40:43], v[224:227], v[208:211], v[40:43]
  s_nop 9
  v_mfma_f32_16x16x32_bf16 v[44:47], v[228:231], v[208:211], v[44:47]
  s_nop 9
  v_mfma_f32_16x16x32_bf16 v[48:51], v[232:235], v[208:211], v[48:51]
  s_nop 9
  v_mfma_f32_16x16x32_bf16 v[52:55], v[236:239], v[208:211], v[52:55]
  s_nop 9
  v_mfma_f32_16x16x32_bf16 v[56:59], v[220:223], v[212:215], v[56:59]
  s_nop 9
  v_mfma_f32_16x16x32_bf16 v[60:63], v[224:227], v[212:215], v[60:63]
  s_nop 9
  v_mfma_f32_16x16x32_bf16 v[64:67], v[228:231], v[212:215], v[64:67]
  s_nop 9
  v_mfma_f32_16x16x32_bf16 v[68:71], v[232:235], v[212:215], v[68:71]
  s_nop 9
  v_mfma_f32_16x16x32_bf16 v[72:75], v[236:239], v[212:215], v[72:75]
  s_nop 9
  v_mfma_f32_16x16x32_bf16 v[76:79], v[220:223], v[216:219], v[76:79]
  s_nop 9
  v_mfma_f32_16x16x32_bf16 v[80:83], v[224:227], v[216:219], v[80:83]
  s_nop 9
  v_mfma_f32_16x16x32_bf16 v[84:87], v[228:231], v[216:219], v[84:87]
  s_nop 9
  v_mfma_f32_16x16x32_bf16 v[88:91], v[232:235], v[216:219], v[88:91]
  s_nop 9
  v_mfma_f32_16x16x32_bf16 v[92:95], v[236:239], v[216:219], v[92:95]
  s_nop 9
  s_setprio 3
  s_mul_i32 s34, s50, 20480
  v_add_u32 v12, s34, v2
  v_mul_f32 v6, 1069066811, v6
  v_exp_f32 v6, v6
  s_nop 0
  v_add_f32 v6, 1.0, v6
  v_rcp_f32 v6, v6
  ds_write_b128 v12, v[16:19] offset:0
  ds_write_b128 v12, v[20:23] offset:1024
  ds_write_b128 v12, v[24:27] offset:2048
  ds_write_b128 v12, v[28:31] offset:3072
  ds_write_b128 v12, v[32:35] offset:4096
  ds_write_b128 v12, v[36:39] offset:5120
  ds_write_b128 v12, v[40:43] offset:6144
  ds_write_b128 v12, v[44:47] offset:7168
  ds_write_b128 v12, v[48:51] offset:8192
  ds_write_b128 v12, v[52:55] offset:9216
  ds_write_b128 v12, v[56:59] offset:10240
  ds_write_b128 v12, v[60:63] offset:11264
  ds_write_b128 v12, v[64:67] offset:12288
  ds_write_b128 v12, v[68:71] offset:13312
  ds_write_b128 v12, v[72:75] offset:14336
  ds_write_b128 v12, v[76:79] offset:15360
  ds_write_b128 v12, v[80:83] offset:16384
  ds_write_b128 v12, v[84:87] offset:17408
  ds_write_b128 v12, v[88:91] offset:18432
  ds_write_b128 v12, v[92:95] offset:19456
  v_mov_b32 v13, 1
  s_mul_i32 s34, s50, 5120
  v_add_u32 v12, s34, v2
  v_add_u32 v14, 40960, v12
  s_waitcnt lgkmcnt(0)
  ds_add_u32 v4, v13
  s_setprio 0
poll_2:
  ds_read_b32 v13, v4 offset:0
  s_waitcnt lgkmcnt(0)
  v_readfirstlane_b32 s36, v13
  s_cmp_lt_u32 s36, 256
  s_cbranch_scc1 poll_2
  s_setprio 3
  ds_read_b128 v[16:19], v12 offset:0
  ds_read_b128 v[36:39], v12 offset:20480
  ds_read_b128 v[56:59], v14 offset:0
  ds_read_b128 v[76:79], v14 offset:20480
  ds_read_b128 v[20:23], v12 offset:1024
  ds_read_b128 v[40:43], v12 offset:21504
  ds_read_b128 v[60:63], v14 offset:1024
  ds_read_b128 v[80:83], v14 offset:21504
  ds_read_b128 v[24:27], v12 offset:2048
  ds_read_b128 v[44:47], v12 offset:22528
  ds_read_b128 v[64:67], v14 offset:2048
  ds_read_b128 v[84:87], v14 offset:22528
  s_waitcnt lgkmcnt(4)
  ds_read_b128 v[28:31], v12 offset:3072
  ds_read_b128 v[48:51], v12 offset:23552
  ds_read_b128 v[68:71], v14 offset:3072
  ds_read_b128 v[88:91], v14 offset:23552
  ds_read_b128 v[32:35], v12 offset:4096
  ds_read_b128 v[52:55], v12 offset:24576
  ds_read_b128 v[72:75], v14 offset:4096
  ds_read_b128 v[92:95], v14 offset:24576
  s_lshl_b32 s35, s23, 2
  s_add_u32 s35, s35, s50
  s_lshl_b32 s35, s35, 3
  s_add_u32 s35, s35, s24
  s_mul_i32 s35, s35, 2560
  s_add_u32 s35, s35, 16777216
  v_lshrrev_b32 v15, 1, v2
  s_waitcnt lgkmcnt(0)
  v_pk_add_f32 v[16:17], v[16:17], v[36:37]
  v_pk_add_f32 v[56:57], v[56:57], v[76:77]
  v_pk_add_f32 v[18:19], v[18:19], v[38:39]
  v_pk_add_f32 v[58:59], v[58:59], v[78:79]
  v_pk_add_f32 v[16:17], v[16:17], v[56:57]
  v_pk_add_f32 v[18:19], v[18:19], v[58:59]
  v_pk_mul_f32 v[16:17], v[16:17], v[6:7] op_sel_hi:[1,0]
  v_pk_mul_f32 v[18:19], v[18:19], v[6:7] op_sel_hi:[1,0]
  v_cvt_pk_bf16_f32 v96, v16, v17
  v_cvt_pk_bf16_f32 v97, v18, v19
  v_pk_add_f32 v[20:21], v[20:21], v[40:41]
  v_pk_add_f32 v[60:61], v[60:61], v[80:81]
  v_pk_add_f32 v[22:23], v[22:23], v[42:43]
  v_pk_add_f32 v[62:63], v[62:63], v[82:83]
  v_pk_add_f32 v[20:21], v[20:21], v[60:61]
  v_pk_add_f32 v[22:23], v[22:23], v[62:63]
  v_pk_mul_f32 v[20:21], v[20:21], v[6:7] op_sel_hi:[1,0]
  v_pk_mul_f32 v[22:23], v[22:23], v[6:7] op_sel_hi:[1,0]
  v_cvt_pk_bf16_f32 v98, v20, v21
  v_cvt_pk_bf16_f32 v99, v22, v23
  buffer_store_dwordx4 v[96:99], v2, s[16:19], s35 offen offset:0 sc1
  v_pk_add_f32 v[24:25], v[24:25], v[44:45]
  v_pk_add_f32 v[64:65], v[64:65], v[84:85]
  v_pk_add_f32 v[26:27], v[26:27], v[46:47]
  v_pk_add_f32 v[66:67], v[66:67], v[86:87]
  v_pk_add_f32 v[24:25], v[24:25], v[64:65]
  v_pk_add_f32 v[26:27], v[26:27], v[66:67]
  v_pk_mul_f32 v[24:25], v[24:25], v[6:7] op_sel_hi:[1,0]
  v_pk_mul_f32 v[26:27], v[26:27], v[6:7] op_sel_hi:[1,0]
  v_cvt_pk_bf16_f32 v100, v24, v25
  v_cvt_pk_bf16_f32 v101, v26, v27
  v_pk_add_f32 v[28:29], v[28:29], v[48:49]
  v_pk_add_f32 v[68:69], v[68:69], v[88:89]
  v_pk_add_f32 v[30:31], v[30:31], v[50:51]
  v_pk_add_f32 v[70:71], v[70:71], v[90:91]
  v_pk_add_f32 v[28:29], v[28:29], v[68:69]
  v_pk_add_f32 v[30:31], v[30:31], v[70:71]
  v_pk_mul_f32 v[28:29], v[28:29], v[6:7] op_sel_hi:[1,0]
  v_pk_mul_f32 v[30:31], v[30:31], v[6:7] op_sel_hi:[1,0]
  v_cvt_pk_bf16_f32 v102, v28, v29
  v_cvt_pk_bf16_f32 v103, v30, v31
  buffer_store_dwordx4 v[100:103], v2, s[16:19], s35 offen offset:1024 sc1
  v_pk_add_f32 v[32:33], v[32:33], v[52:53]
  v_pk_add_f32 v[72:73], v[72:73], v[92:93]
  v_pk_add_f32 v[34:35], v[34:35], v[54:55]
  v_pk_add_f32 v[74:75], v[74:75], v[94:95]
  v_pk_add_f32 v[32:33], v[32:33], v[72:73]
  v_pk_add_f32 v[34:35], v[34:35], v[74:75]
  v_pk_mul_f32 v[32:33], v[32:33], v[6:7] op_sel_hi:[1,0]
  v_pk_mul_f32 v[34:35], v[34:35], v[6:7] op_sel_hi:[1,0]
  v_cvt_pk_bf16_f32 v104, v32, v33
  v_cvt_pk_bf16_f32 v105, v34, v35
  buffer_store_dwordx2 v[104:105], v15, s[16:19], s35 offen offset:2048 sc1
kd_kernel_end:
  s_endpgm

.globl ke_kernel
.p2align 8
.type ke_kernel,@function
ke_kernel:

  s_cmp_ge_u32 s2, 256
  s_cbranch_scc1 ke_kernel_end
  s_load_dwordx2 s[60:61], s[0:1], 96
  s_load_dwordx2 s[62:63], s[0:1], 80
  v_lshrrev_b32 v4, 6, v0
  v_and_b32 v1, 63, v0
  v_readfirstlane_b32 s20, v4
  s_and_b32 s21, s2, 7
  s_lshr_b32 s22, s2, 3
  s_lshr_b32 s23, s21, 1
  s_lshl_b32 s23, s23, 3
  s_and_b32 s24, s22, 7
  s_add_u32 s23, s23, s24
  s_and_b32 s24, s21, 1
  s_lshl_b32 s24, s24, 2
  s_lshr_b32 s25, s22, 3
  s_add_u32 s24, s24, s25
  v_lshlrev_b32 v2, 4, v1
  s_mul_i32 s29, s20, 5
  s_lshl_b32 s30, s23, 2
  s_mul_i32 s30, s30, 20480
  s_lshl_b32 s27, s29, 10
  s_add_u32 s40, s27, s30
  s_add_u32 s40, s40, 9437184
  s_mov_b32 s46, s40
  s_add_u32 s47, s20, 0
  s_and_b32 s47, s47, 3
  s_mul_i32 s47, s47, 20480
  s_add_u32 s40, s46, s47
  s_add_u32 s47, s20, 1
  s_and_b32 s47, s47, 3
  s_mul_i32 s47, s47, 20480
  s_add_u32 s41, s46, s47
  s_add_u32 s47, s20, 2
  s_and_b32 s47, s47, 3
  s_mul_i32 s47, s47, 20480
  s_add_u32 s42, s46, s47
  s_add_u32 s47, s20, 3
  s_and_b32 s47, s47, 3
  s_mul_i32 s47, s47, 20480
  s_add_u32 s43, s46, s47
  s_mul_i32 s28, s29, 40960
  s_mul_i32 s30, s24, 5120
  s_add_u32 s44, s28, s30
  s_add_u32 s44, s44, 14548992
  s_add_u32 s45, s44, 4096
  v_and_b32 v3, 15, v1
  s_lshl_b32 s32, s23, 2
  s_add_u32 s32, s32, s20
  s_lshl_b32 s32, s32, 3
  s_add_u32 s32, s32, s24
  s_mul_i32 s32, s32, 2560
  s_add_u32 s32, s32, 16777216
  v_lshrrev_b32 v8, 1, v2
  s_waitcnt lgkmcnt(0)
  s_mov_b32 s16, s60
  s_and_b32 s17, s61, 0xffff
  s_mov_b32 s18, 23068672
  s_mov_b32 s19, 0x20000
  s_mov_b32 s12, s62
  s_and_b32 s13, s63, 0xffff
  s_mov_b32 s14, 2621440
  s_mov_b32 s15, 0x20000
  buffer_load_dwordx4 a[0:3], v2, s[16:19], s44 offen offset:0
  buffer_load_dwordx4 a[20:23], v2, s[16:19], s40 offen offset:0
  buffer_load_dwordx4 a[4:7], v2, s[16:19], s44 offen offset:1024
  buffer_load_dwordx4 a[24:27], v2, s[16:19], s41 offen offset:0
  buffer_load_dwordx4 a[8:11], v2, s[16:19], s44 offen offset:2048
  buffer_load_dwordx4 a[28:31], v2, s[16:19], s42 offen offset:0
  buffer_load_dwordx4 a[12:15], v2, s[16:19], s44 offen offset:3072
  buffer_load_dwordx4 a[32:35], v2, s[16:19], s43 offen offset:0
  buffer_load_dwordx4 a[16:19], v2, s[16:19], s45 offen offset:0
  s_add_u32 s44, s44, 40960
  s_add_u32 s45, s45, 40960
  buffer_load_dwordx4 a[36:39], v2, s[16:19], s44 offen offset:0
  buffer_load_dwordx4 a[56:59], v2, s[16:19], s40 offen offset:1024
  buffer_load_dwordx4 a[40:43], v2, s[16:19], s44 offen offset:1024
  buffer_load_dwordx4 a[60:63], v2, s[16:19], s41 offen offset:1024
  buffer_load_dwordx4 a[44:47], v2, s[16:19], s44 offen offset:2048
  buffer_load_dwordx4 a[64:67], v2, s[16:19], s42 offen offset:1024
  buffer_load_dwordx4 a[48:51], v2, s[16:19], s44 offen offset:3072
  buffer_load_dwordx4 a[68:71], v2, s[16:19], s43 offen offset:1024
  buffer_load_dwordx4 a[52:55], v2, s[16:19], s45 offen offset:0
  s_add_u32 s44, s44, 40960
  s_add_u32 s45, s45, 40960
  s_waitcnt vmcnt(9)
  v_mfma_f32_16x16x32_bf16 v[16:19], a[0:3], a[20:23], 0
  v_mfma_f32_16x16x32_bf16 v[20:23], a[4:7], a[20:23], 0
  buffer_load_dwordx4 a[72:75], v2, s[16:19], s44 offen offset:0
  v_mfma_f32_16x16x32_bf16 v[24:27], a[8:11], a[20:23], 0
  v_mfma_f32_16x16x32_bf16 v[28:31], a[12:15], a[20:23], 0
  buffer_load_dwordx4 a[92:95], v2, s[16:19], s40 offen offset:2048
  v_mfma_f32_16x16x32_bf16 v[32:35], a[16:19], a[20:23], 0
  v_mfma_f32_16x16x32_bf16 v[36:39], a[0:3], a[24:27], 0
  buffer_load_dwordx4 a[76:79], v2, s[16:19], s44 offen offset:1024
  v_mfma_f32_16x16x32_bf16 v[40:43], a[4:7], a[24:27], 0
  v_mfma_f32_16x16x32_bf16 v[44:47], a[8:11], a[24:27], 0
  buffer_load_dwordx4 a[96:99], v2, s[16:19], s41 offen offset:2048
  v_mfma_f32_16x16x32_bf16 v[48:51], a[12:15], a[24:27], 0
  v_mfma_f32_16x16x32_bf16 v[52:55], a[16:19], a[24:27], 0
  buffer_load_dwordx4 a[80:83], v2, s[16:19], s44 offen offset:2048
  v_mfma_f32_16x16x32_bf16 v[56:59], a[0:3], a[28:31], 0
  v_mfma_f32_16x16x32_bf16 v[60:63], a[4:7], a[28:31], 0
  buffer_load_dwordx4 a[100:103], v2, s[16:19], s42 offen offset:2048
  v_mfma_f32_16x16x32_bf16 v[64:67], a[8:11], a[28:31], 0
  v_mfma_f32_16x16x32_bf16 v[68:71], a[12:15], a[28:31], 0
  buffer_load_dwordx4 a[84:87], v2, s[16:19], s44 offen offset:3072
  v_mfma_f32_16x16x32_bf16 v[72:75], a[16:19], a[28:31], 0
  v_mfma_f32_16x16x32_bf16 v[76:79], a[0:3], a[32:35], 0
  buffer_load_dwordx4 a[104:107], v2, s[16:19], s43 offen offset:2048
  v_mfma_f32_16x16x32_bf16 v[80:83], a[4:7], a[32:35], 0
  v_mfma_f32_16x16x32_bf16 v[84:87], a[8:11], a[32:35], 0
  buffer_load_dwordx4 a[88:91], v2, s[16:19], s45 offen offset:0
  s_add_u32 s44, s44, 40960
  s_add_u32 s45, s45, 40960
  v_mfma_f32_16x16x32_bf16 v[88:91], a[12:15], a[32:35], 0
  v_mfma_f32_16x16x32_bf16 v[92:95], a[16:19], a[32:35], 0
  s_waitcnt vmcnt(9)
  v_mfma_f32_16x16x32_bf16 v[16:19], a[36:39], a[56:59], v[16:19]
  v_mfma_f32_16x16x32_bf16 v[20:23], a[40:43], a[56:59], v[20:23]
  buffer_load_dwordx4 a[108:111], v2, s[16:19], s44 offen offset:0
  v_mfma_f32_16x16x32_bf16 v[24:27], a[44:47], a[56:59], v[24:27]
  v_mfma_f32_16x16x32_bf16 v[28:31], a[48:51], a[56:59], v[28:31]
  buffer_load_dwordx4 a[128:131], v2, s[16:19], s40 offen offset:3072
  v_mfma_f32_16x16x32_bf16 v[32:35], a[52:55], a[56:59], v[32:35]
  v_mfma_f32_16x16x32_bf16 v[36:39], a[36:39], a[60:63], v[36:39]
  buffer_load_dwordx4 a[112:115], v2, s[16:19], s44 offen offset:1024
  v_mfma_f32_16x16x32_bf16 v[40:43], a[40:43], a[60:63], v[40:43]
  v_mfma_f32_16x16x32_bf16 v[44:47], a[44:47], a[60:63], v[44:47]
  buffer_load_dwordx4 a[132:135], v2, s[16:19], s41 offen offset:3072
  v_mfma_f32_16x16x32_bf16 v[48:51], a[48:51], a[60:63], v[48:51]
  v_mfma_f32_16x16x32_bf16 v[52:55], a[52:55], a[60:63], v[52:55]
  buffer_load_dwordx4 a[116:119], v2, s[16:19], s44 offen offset:2048
  v_mfma_f32_16x16x32_bf16 v[56:59], a[36:39], a[64:67], v[56:59]
  v_mfma_f32_16x16x32_bf16 v[60:63], a[40:43], a[64:67], v[60:63]
  buffer_load_dwordx4 a[136:139], v2, s[16:19], s42 offen offset:3072
  v_mfma_f32_16x16x32_bf16 v[64:67], a[44:47], a[64:67], v[64:67]
  v_mfma_f32_16x16x32_bf16 v[68:71], a[48:51], a[64:67], v[68:71]
  buffer_load_dwordx4 a[120:123], v2, s[16:19], s44 offen offset:3072
  v_mfma_f32_16x16x32_bf16 v[72:75], a[52:55], a[64:67], v[72:75]
  v_mfma_f32_16x16x32_bf16 v[76:79], a[36:39], a[68:71], v[76:79]
  buffer_load_dwordx4 a[140:143], v2, s[16:19], s43 offen offset:3072
  v_mfma_f32_16x16x32_bf16 v[80:83], a[40:43], a[68:71], v[80:83]
  v_mfma_f32_16x16x32_bf16 v[84:87], a[44:47], a[68:71], v[84:87]
  buffer_load_dwordx4 a[124:127], v2, s[16:19], s45 offen offset:0
  s_add_u32 s44, s44, 40960
  s_add_u32 s45, s45, 40960
  s_add_u32 s40, s40, 4096
  s_add_u32 s41, s41, 4096
  s_add_u32 s42, s42, 4096
  s_add_u32 s43, s43, 4096
  v_mfma_f32_16x16x32_bf16 v[88:91], a[48:51], a[68:71], v[88:91]
  v_mfma_f32_16x16x32_bf16 v[92:95], a[52:55], a[68:71], v[92:95]
  s_waitcnt vmcnt(9)
  v_mfma_f32_16x16x32_bf16 v[16:19], a[72:75], a[92:95], v[16:19]
  v_mfma_f32_16x16x32_bf16 v[20:23], a[76:79], a[92:95], v[20:23]
  buffer_load_dwordx4 a[144:147], v2, s[16:19], s44 offen offset:0
  v_mfma_f32_16x16x32_bf16 v[24:27], a[80:83], a[92:95], v[24:27]
  v_mfma_f32_16x16x32_bf16 v[28:31], a[84:87], a[92:95], v[28:31]
  buffer_load_dwordx4 a[164:167], v2, s[16:19], s40 offen offset:0
  v_mfma_f32_16x16x32_bf16 v[32:35], a[88:91], a[92:95], v[32:35]
  v_mfma_f32_16x16x32_bf16 v[36:39], a[72:75], a[96:99], v[36:39]
  buffer_load_dwordx4 a[148:151], v2, s[16:19], s44 offen offset:1024
  v_mfma_f32_16x16x32_bf16 v[40:43], a[76:79], a[96:99], v[40:43]
  v_mfma_f32_16x16x32_bf16 v[44:47], a[80:83], a[96:99], v[44:47]
  buffer_load_dwordx4 a[168:171], v2, s[16:19], s41 offen offset:0
  v_mfma_f32_16x16x32_bf16 v[48:51], a[84:87], a[96:99], v[48:51]
  v_mfma_f32_16x16x32_bf16 v[52:55], a[88:91], a[96:99], v[52:55]
  buffer_load_dwordx4 a[152:155], v2, s[16:19], s44 offen offset:2048
  v_mfma_f32_16x16x32_bf16 v[56:59], a[72:75], a[100:103], v[56:59]
  v_mfma_f32_16x16x32_bf16 v[60:63], a[76:79], a[100:103], v[60:63]
  buffer_load_dwordx4 a[172:175], v2, s[16:19], s42 offen offset:0
  v_mfma_f32_16x16x32_bf16 v[64:67], a[80:83], a[100:103], v[64:67]
  v_mfma_f32_16x16x32_bf16 v[68:71], a[84:87], a[100:103], v[68:71]
  buffer_load_dwordx4 a[156:159], v2, s[16:19], s44 offen offset:3072
  v_mfma_f32_16x16x32_bf16 v[72:75], a[88:91], a[100:103], v[72:75]
  v_mfma_f32_16x16x32_bf16 v[76:79], a[72:75], a[104:107], v[76:79]
  buffer_load_dwordx4 a[176:179], v2, s[16:19], s43 offen offset:0
  v_mfma_f32_16x16x32_bf16 v[80:83], a[76:79], a[104:107], v[80:83]
  v_mfma_f32_16x16x32_bf16 v[84:87], a[80:83], a[104:107], v[84:87]
  buffer_load_dwordx4 a[160:163], v2, s[16:19], s45 offen offset:0
  v_mfma_f32_16x16x32_bf16 v[88:91], a[84:87], a[104:107], v[88:91]
  v_mfma_f32_16x16x32_bf16 v[92:95], a[88:91], a[104:107], v[92:95]
  s_waitcnt vmcnt(9)
  v_mfma_f32_16x16x32_bf16 v[16:19], a[108:111], a[128:131], v[16:19]
  v_mfma_f32_16x16x32_bf16 v[20:23], a[112:115], a[128:131], v[20:23]
  buffer_load_dwordx4 v[96:99], v2, s[16:19], s32 offen
  v_mfma_f32_16x16x32_bf16 v[24:27], a[116:119], a[128:131], v[24:27]
  v_mfma_f32_16x16x32_bf16 v[28:31], a[120:123], a[128:131], v[28:31]
  buffer_load_dwordx4 v[100:103], v2, s[16:19], s32 offen offset:1024
  v_mfma_f32_16x16x32_bf16 v[32:35], a[124:127], a[128:131], v[32:35]
  v_mfma_f32_16x16x32_bf16 v[36:39], a[108:111], a[132:135], v[36:39]
  buffer_load_dwordx2 v[104:105], v8, s[16:19], s32 offen offset:2048
  v_mfma_f32_16x16x32_bf16 v[40:43], a[112:115], a[132:135], v[40:43]
  v_mfma_f32_16x16x32_bf16 v[44:47], a[116:119], a[132:135], v[44:47]
  v_mfma_f32_16x16x32_bf16 v[48:51], a[120:123], a[132:135], v[48:51]
  v_mfma_f32_16x16x32_bf16 v[52:55], a[124:127], a[132:135], v[52:55]
  v_mfma_f32_16x16x32_bf16 v[56:59], a[108:111], a[136:139], v[56:59]
  v_mfma_f32_16x16x32_bf16 v[60:63], a[112:115], a[136:139], v[60:63]
  v_mfma_f32_16x16x32_bf16 v[64:67], a[116:119], a[136:139], v[64:67]
  v_mfma_f32_16x16x32_bf16 v[68:71], a[120:123], a[136:139], v[68:71]
  v_mfma_f32_16x16x32_bf16 v[72:75], a[124:127], a[136:139], v[72:75]
  v_mfma_f32_16x16x32_bf16 v[76:79], a[108:111], a[140:143], v[76:79]
  v_mfma_f32_16x16x32_bf16 v[80:83], a[112:115], a[140:143], v[80:83]
  v_mfma_f32_16x16x32_bf16 v[84:87], a[116:119], a[140:143], v[84:87]
  v_mfma_f32_16x16x32_bf16 v[88:91], a[120:123], a[140:143], v[88:91]
  v_mfma_f32_16x16x32_bf16 v[92:95], a[124:127], a[140:143], v[92:95]
  s_waitcnt vmcnt(3)
  v_mfma_f32_16x16x32_bf16 v[16:19], a[144:147], a[164:167], v[16:19]
  v_mfma_f32_16x16x32_bf16 v[20:23], a[148:151], a[164:167], v[20:23]
  v_mfma_f32_16x16x32_bf16 v[24:27], a[152:155], a[164:167], v[24:27]
  v_mfma_f32_16x16x32_bf16 v[28:31], a[156:159], a[164:167], v[28:31]
  v_mfma_f32_16x16x32_bf16 v[32:35], a[160:163], a[164:167], v[32:35]
  v_mfma_f32_16x16x32_bf16 v[36:39], a[144:147], a[168:171], v[36:39]
  v_mfma_f32_16x16x32_bf16 v[40:43], a[148:151], a[168:171], v[40:43]
  v_mfma_f32_16x16x32_bf16 v[44:47], a[152:155], a[168:171], v[44:47]
  v_mfma_f32_16x16x32_bf16 v[48:51], a[156:159], a[168:171], v[48:51]
  v_mfma_f32_16x16x32_bf16 v[52:55], a[160:163], a[168:171], v[52:55]
  v_mfma_f32_16x16x32_bf16 v[56:59], a[144:147], a[172:175], v[56:59]
  v_mfma_f32_16x16x32_bf16 v[60:63], a[148:151], a[172:175], v[60:63]
  v_mfma_f32_16x16x32_bf16 v[64:67], a[152:155], a[172:175], v[64:67]
  v_mfma_f32_16x16x32_bf16 v[68:71], a[156:159], a[172:175], v[68:71]
  v_mfma_f32_16x16x32_bf16 v[72:75], a[160:163], a[172:175], v[72:75]
  v_mfma_f32_16x16x32_bf16 v[76:79], a[144:147], a[176:179], v[76:79]
  v_mfma_f32_16x16x32_bf16 v[80:83], a[148:151], a[176:179], v[80:83]
  v_mfma_f32_16x16x32_bf16 v[84:87], a[152:155], a[176:179], v[84:87]
  v_mfma_f32_16x16x32_bf16 v[88:91], a[156:159], a[176:179], v[88:91]
  v_mfma_f32_16x16x32_bf16 v[92:95], a[160:163], a[176:179], v[92:95]
  s_add_u32 s47, s20, 1
  s_and_b32 s47, s47, 3
  s_mul_i32 s48, s47, 5120
  s_mul_i32 s49, s20, 20480
  s_add_u32 s48, s48, s49
  v_add_u32 v9, s48, v2
  s_mul_i32 s48, s47, 20480
  s_mul_i32 s49, s20, 5120
  s_add_u32 s48, s48, s49
  v_add_u32 v5, s48, v2
  s_add_u32 s47, s20, 2
  s_and_b32 s47, s47, 3
  s_mul_i32 s48, s47, 5120
  s_mul_i32 s49, s20, 20480
  s_add_u32 s48, s48, s49
  v_add_u32 v10, s48, v2
  s_mul_i32 s48, s47, 20480
  s_mul_i32 s49, s20, 5120
  s_add_u32 s48, s48, s49
  v_add_u32 v6, s48, v2
  s_add_u32 s47, s20, 3
  s_and_b32 s47, s47, 3
  s_mul_i32 s48, s47, 5120
  s_mul_i32 s49, s20, 20480
  s_add_u32 s48, s48, s49
  v_add_u32 v11, s48, v2
  s_mul_i32 s48, s47, 20480
  s_mul_i32 s49, s20, 5120
  s_add_u32 s48, s48, s49
  v_add_u32 v7, s48, v2
  ds_write_b128 v9, v[36:39] offset:0
  ds_write_b128 v9, v[40:43] offset:1024
  ds_write_b128 v9, v[44:47] offset:2048
  ds_write_b128 v9, v[48:51] offset:3072
  ds_write_b128 v9, v[52:55] offset:4096
  ds_write_b128 v10, v[56:59] offset:0
  ds_write_b128 v10, v[60:63] offset:1024
  ds_write_b128 v10, v[64:67] offset:2048
  ds_write_b128 v10, v[68:71] offset:3072
  ds_write_b128 v10, v[72:75] offset:4096
  ds_write_b128 v11, v[76:79] offset:0
  ds_write_b128 v11, v[80:83] offset:1024
  ds_write_b128 v11, v[84:87] offset:2048
  ds_write_b128 v11, v[88:91] offset:3072
  ds_write_b128 v11, v[92:95] offset:4096
  s_lshl_b32 s35, s23, 6
  s_lshl_b32 s36, s20, 4
  s_add_u32 s35, s35, s36
  s_mul_i32 s35, s35, 1280
  s_mul_i32 s36, s24, 160
  s_add_u32 s35, s35, s36
  s_movk_i32 s36, 1280
  v_mul_lo_u32 v12, v3, s36
  v_lshrrev_b32 v13, 4, v1
  v_lshl_add_u32 v12, v13, 3, v12
  s_waitcnt lgkmcnt(0)
  s_barrier
  ds_read_b128 v[36:39], v5 offset:0
  ds_read_b128 v[56:59], v6 offset:0
  ds_read_b128 v[76:79], v7 offset:0
  ds_read_b128 v[40:43], v5 offset:1024
  ds_read_b128 v[60:63], v6 offset:1024
  ds_read_b128 v[80:83], v7 offset:1024
  ds_read_b128 v[44:47], v5 offset:2048
  ds_read_b128 v[64:67], v6 offset:2048
  ds_read_b128 v[84:87], v7 offset:2048
  ds_read_b128 v[48:51], v5 offset:3072
  ds_read_b128 v[68:71], v6 offset:3072
  ds_read_b128 v[88:91], v7 offset:3072
  ds_read_b128 v[52:55], v5 offset:4096
  ds_read_b128 v[72:75], v6 offset:4096
  ds_read_b128 v[92:95], v7 offset:4096
  s_waitcnt vmcnt(0)
  s_waitcnt lgkmcnt(12)
  v_pk_add_f32 v[16:17], v[16:17], v[36:37]
  v_pk_add_f32 v[56:57], v[56:57], v[76:77]
  v_pk_add_f32 v[18:19], v[18:19], v[38:39]
  v_pk_add_f32 v[58:59], v[58:59], v[78:79]
  v_lshlrev_b32 v108, 16, v96
  v_and_b32 v109, 0xffff0000, v96
  v_lshlrev_b32 v110, 16, v97
  v_and_b32 v111, 0xffff0000, v97
  v_pk_add_f32 v[56:57], v[56:57], v[108:109]
  v_pk_add_f32 v[58:59], v[58:59], v[110:111]
  v_pk_add_f32 v[16:17], v[16:17], v[56:57]
  v_pk_add_f32 v[18:19], v[18:19], v[58:59]
  v_cvt_pk_bf16_f32 v16, v16, v17
  v_cvt_pk_bf16_f32 v17, v18, v19
  buffer_store_dwordx2 v[16:17], v12, s[12:15], s35 offen offset:0
  s_waitcnt lgkmcnt(9)
  v_pk_add_f32 v[20:21], v[20:21], v[40:41]
  v_pk_add_f32 v[60:61], v[60:61], v[80:81]
  v_pk_add_f32 v[22:23], v[22:23], v[42:43]
  v_pk_add_f32 v[62:63], v[62:63], v[82:83]
  v_lshlrev_b32 v108, 16, v98
  v_and_b32 v109, 0xffff0000, v98
  v_lshlrev_b32 v110, 16, v99
  v_and_b32 v111, 0xffff0000, v99
  v_pk_add_f32 v[60:61], v[60:61], v[108:109]
  v_pk_add_f32 v[62:63], v[62:63], v[110:111]
  v_pk_add_f32 v[20:21], v[20:21], v[60:61]
  v_pk_add_f32 v[22:23], v[22:23], v[62:63]
  v_cvt_pk_bf16_f32 v20, v20, v21
  v_cvt_pk_bf16_f32 v21, v22, v23
  buffer_store_dwordx2 v[20:21], v12, s[12:15], s35 offen offset:32
  s_waitcnt lgkmcnt(6)
  v_pk_add_f32 v[24:25], v[24:25], v[44:45]
  v_pk_add_f32 v[64:65], v[64:65], v[84:85]
  v_pk_add_f32 v[26:27], v[26:27], v[46:47]
  v_pk_add_f32 v[66:67], v[66:67], v[86:87]
  v_lshlrev_b32 v108, 16, v100
  v_and_b32 v109, 0xffff0000, v100
  v_lshlrev_b32 v110, 16, v101
  v_and_b32 v111, 0xffff0000, v101
  v_pk_add_f32 v[64:65], v[64:65], v[108:109]
  v_pk_add_f32 v[66:67], v[66:67], v[110:111]
  v_pk_add_f32 v[24:25], v[24:25], v[64:65]
  v_pk_add_f32 v[26:27], v[26:27], v[66:67]
  v_cvt_pk_bf16_f32 v24, v24, v25
  v_cvt_pk_bf16_f32 v25, v26, v27
  buffer_store_dwordx2 v[24:25], v12, s[12:15], s35 offen offset:64
  s_waitcnt lgkmcnt(3)
  v_pk_add_f32 v[28:29], v[28:29], v[48:49]
  v_pk_add_f32 v[68:69], v[68:69], v[88:89]
  v_pk_add_f32 v[30:31], v[30:31], v[50:51]
  v_pk_add_f32 v[70:71], v[70:71], v[90:91]
  v_lshlrev_b32 v108, 16, v102
  v_and_b32 v109, 0xffff0000, v102
  v_lshlrev_b32 v110, 16, v103
  v_and_b32 v111, 0xffff0000, v103
  v_pk_add_f32 v[68:69], v[68:69], v[108:109]
  v_pk_add_f32 v[70:71], v[70:71], v[110:111]
  v_pk_add_f32 v[28:29], v[28:29], v[68:69]
  v_pk_add_f32 v[30:31], v[30:31], v[70:71]
  v_cvt_pk_bf16_f32 v28, v28, v29
  v_cvt_pk_bf16_f32 v29, v30, v31
  buffer_store_dwordx2 v[28:29], v12, s[12:15], s35 offen offset:96
  s_waitcnt lgkmcnt(0)
  v_pk_add_f32 v[32:33], v[32:33], v[52:53]
  v_pk_add_f32 v[72:73], v[72:73], v[92:93]
  v_pk_add_f32 v[34:35], v[34:35], v[54:55]
  v_pk_add_f32 v[74:75], v[74:75], v[94:95]
  v_lshlrev_b32 v108, 16, v104
  v_and_b32 v109, 0xffff0000, v104
  v_lshlrev_b32 v110, 16, v105
  v_and_b32 v111, 0xffff0000, v105
  v_pk_add_f32 v[72:73], v[72:73], v[108:109]
  v_pk_add_f32 v[74:75], v[74:75], v[110:111]
  v_pk_add_f32 v[32:33], v[32:33], v[72:73]
  v_pk_add_f32 v[34:35], v[34:35], v[74:75]
  v_cvt_pk_bf16_f32 v32, v32, v33
  v_cvt_pk_bf16_f32 v33, v34, v35
  buffer_store_dwordx2 v[32:33], v12, s[12:15], s35 offen offset:128
ke_kernel_end:
  s_endpgm

.section .rodata,"a"
.p2align 6
.amdhsa_kernel k1_kernel
  .amdhsa_next_free_vgpr 256
  .amdhsa_next_free_sgpr 102
  .amdhsa_accum_offset 256
  .amdhsa_group_segment_fixed_size 0
  .amdhsa_kernarg_size 104
  .amdhsa_user_sgpr_count 2
  .amdhsa_user_sgpr_kernarg_segment_ptr 1
  .amdhsa_system_sgpr_workgroup_id_x 1
  .amdhsa_float_denorm_mode_32 3
  .amdhsa_float_denorm_mode_16_64 3
.end_amdhsa_kernel

.p2align 6
.amdhsa_kernel kd_kernel
  .amdhsa_next_free_vgpr 256
  .amdhsa_next_free_sgpr 102
  .amdhsa_accum_offset 256
  .amdhsa_group_segment_fixed_size 0
  .amdhsa_kernarg_size 104
  .amdhsa_user_sgpr_count 2
  .amdhsa_user_sgpr_kernarg_segment_ptr 1
  .amdhsa_system_sgpr_workgroup_id_x 1
  .amdhsa_float_denorm_mode_32 3
  .amdhsa_float_denorm_mode_16_64 3
.end_amdhsa_kernel

.p2align 6
.amdhsa_kernel ke_kernel
  .amdhsa_next_free_vgpr 300
  .amdhsa_next_free_sgpr 102
  .amdhsa_accum_offset 120
  .amdhsa_group_segment_fixed_size 0
  .amdhsa_kernarg_size 104
  .amdhsa_user_sgpr_count 2
  .amdhsa_user_sgpr_kernarg_segment_ptr 1
  .amdhsa_system_sgpr_workgroup_id_x 1
  .amdhsa_float_denorm_mode_32 3
  .amdhsa_float_denorm_mode_16_64 3
.end_amdhsa_kernel
```
